```python
import torch

def _softmax(x, axis=-1):
    return torch.softmax(x, dim=axis)
def _gelu(x):
    return torch.nn.functional.gelu(x, approximate="tanh")
def _silu(x):
    return torch.nn.functional.silu(x)
def _sigmoid(x):
    return torch.sigmoid(x)
def _layernorm(x, axis=-1, eps=1e-5):
    m = x.mean(dim=axis, keepdim=True)
    v = x.var(dim=axis, keepdim=True, unbiased=False)
    return (x - m) / torch.sqrt(v + eps)
def _scatter_add(tgt, idx, src, axis=0):
    return tgt.clone().index_add_(axis, idx, src)
def _segment_sum(src, seg, n):
    out = torch.zeros((n,) + src.shape[1:], dtype=src.dtype)
    return out.index_add_(0, seg, src)
def _pad(x, pw):
    flat = tuple(v for pair in reversed(pw) for v in pair)
    return torch.nn.functional.pad(x, flat)

kernel_name = 'gated_mix__mha_block__linear_kernel_hedgehog__prompt'

def setup_inputs():

    _w = (lambda a: (lambda t: t.to(torch.bfloat16) if t.is_floating_point() else t)(torch.as_tensor(a)))
    def _A_setup():
        B, S, D, H = 1, 2048, 640, 32
        return {
            "x": _w((lambda *s: torch.randn(*s, dtype=torch.bfloat16) * 0.05)(B, S, D)),
            "wqkv": _w((lambda *s: torch.randn(*s, dtype=torch.bfloat16) * 0.8)(D, 3 * D)),
            "wo": _w((lambda *s: torch.randn(*s, dtype=torch.bfloat16) * 0.05)(D, D)),
        }
    _A_in = _A_setup()

    def _B_setup():
        B, S, D, H = 1, 2048, 640, 32
        Dh = D // H
        return {
            "x": _w((lambda *s: torch.randn(*s, dtype=torch.bfloat16) * 0.05)(B, S, D)),
            "wqkv": _w((lambda *s: torch.randn(*s, dtype=torch.bfloat16) * 1.6)(D, 3 * D)),
            "w_phi": _w((lambda *s: torch.randn(*s, dtype=torch.bfloat16) * 1.6)(H, Dh, Dh) * (Dh ** -0.5)),
            "wo": _w((lambda *s: torch.randn(*s, dtype=torch.bfloat16) * 0.05)(D, D)),
        }
    _B_in = _B_setup()

    return {
        "A_x": _A_in["x"],
        "A_wqkv": _A_in["wqkv"],
        "A_wo": _A_in["wo"],
        "B_x": _B_in["x"],
        "B_wqkv": _B_in["wqkv"],
        "B_w_phi": _B_in["w_phi"],
        "B_wo": _B_in["wo"],
        "gate_w": _w((lambda *s: torch.randn(*s, dtype=torch.bfloat16) * 0.05)(640) * 16.0),
    }

def reference(A_x, A_wqkv, A_wo, B_x, B_wqkv, B_w_phi, B_wo, gate_w):
    def _A_ref(x, wqkv, wo):
        B, S, D = x.shape
        H = 32
        Dh = D // H
        qkv = (lambda x, *d: x.permute(*d))((x @ wqkv).reshape(B, S, 3, H, Dh), 2, 0, 3, 1, 4)
        q, k, v = qkv[0], qkv[1], qkv[2]
        scores = torch.einsum("bhqd,bhkd->bhqk", q, k) * (Dh ** -0.5)
        p = _softmax(scores, axis=-1)
        o = torch.einsum("bhqk,bhkd->bhqd", p, v)
        return (lambda x, *d: x.permute(*d))(o, 0, 2, 1, 3).reshape(B, S, D) @ wo

    def _B_ref(x, wqkv, w_phi, wo):
        B, S, D = x.shape
        H = 32; Dh = D // H
        qkv = (lambda x, *d: x.permute(*d))((x @ wqkv).reshape(B, S, 3, H, Dh), 2, 0, 3, 1, 4)
        q, k, v = qkv[0], qkv[1], qkv[2]
        pq = torch.einsum("bhsd,hdf->bhsf", q, w_phi)
        pk = torch.einsum("bhsd,hdf->bhsf", k, w_phi)
        phi_q = torch.concatenate([_softmax(pq, axis=-1), _softmax(-pq, axis=-1)], axis=-1)
        phi_k = torch.concatenate([_softmax(pk, axis=-1), _softmax(-pk, axis=-1)], axis=-1)
        kv = torch.einsum("bhsf,bhsd->bhfd", phi_k, v)
        z  = torch.einsum("bhsf->bhf", phi_k)
        num = torch.einsum("bhqf,bhfd->bhqd", phi_q, kv)
        den = torch.einsum("bhqf,bhf->bhq", phi_q, z)[..., None] + 1e-6
        o = num / den
        return (lambda x, *d: x.permute(*d))(o, 0, 2, 1, 3).reshape(B, S, D) @ wo

    x = A_x
    g = _sigmoid((x * gate_w).sum(-1, keepdims=True))
    a = _A_ref(x, A_wqkv, A_wo)
    b = _B_ref(x, B_wqkv, B_w_phi, B_wo)
    return g * a + (1 - g) * b
```

```asm
; @launch grid=(256,1,1) block=(512,1,1) lds=163840
.amdgcn_target "amdgcn-amd-amdhsa--gfx950"
.text
.globl gated_mix__mha_block__linear_kernel_hedgehog__prompt_kernel
.p2align 8
.type gated_mix__mha_block__linear_kernel_hedgehog__prompt_kernel,@function
gated_mix__mha_block__linear_kernel_hedgehog__prompt_kernel:
    s_cmp_ge_u32 s2, 256
    s_cbranch_scc1 L_end1
    s_load_dwordx2 s[28:29], s[0:1], 40
    s_load_dwordx2 s[16:17], s[0:1], 80
    s_getpc_b64 s[60:61]
L_cpf0_pc:
    v_cmp_gt_u32 vcc, 64, v0
    s_cbranch_vccz L_cpf0_done
    v_lshlrev_b32 v36, 7, v0
    v_add_u32 v37, L_p1_x-L_cpf0_pc-5120, v36
    v_cmp_le_u32 vcc, 40, v0
    v_cndmask_b32 v37, v36, v37, vcc
    v_add_u32 v36, L_p1_v-L_cpf0_pc-6656, v36
    v_cmp_le_u32 vcc, 52, v0
    v_cndmask_b32 v36, v37, v36, vcc
    v_min_u32 v36, L_end1-L_cpf0_pc, v36
    global_load_dword v9, v36, s[60:61]
L_cpf0_done:
    s_load_dwordx2 s[24:25], s[0:1], 32
    s_load_dwordx2 s[8:9], s[0:1], 0
    s_load_dwordx2 s[12:13], s[0:1], 8
    s_load_dwordx2 s[32:33], s[0:1], 56
    s_load_dwordx2 s[20:21], s[0:1], 72
    s_mov_b32 s30, 0x6400
    s_mov_b32 s31, 0x20000
    s_mov_b32 s26, 0x258000
    s_mov_b32 s27, 0x20000
    s_mov_b32 s34, 0x500
    s_mov_b32 s35, 0x20000
    s_and_b32 s36, s2, 7
    s_lshr_b32 s37, s2, 3
    v_lshrrev_b32 v1, 6, v0
    v_and_b32 v2, 63, v0
    v_readfirstlane_b32 s38, v1
    s_and_b32 s39, s36, 4
    s_and_b32 s52, s37, 7
    s_lshl1_add_u32 s39, s39, s52
    s_and_b32 s40, s36, 1
    s_and_b32 s52, s36, 2
    s_lshl2_add_u32 s40, s40, s52
    s_lshl_b32 s40, s40, 1
    s_lshr_b32 s52, s37, 3
    s_add_u32 s40, s40, s52
    s_and_b32 s41, s38, 3
    s_lshr_b32 s42, s38, 2
    v_lshlrev_b32 v3, 4, v2
    v_and_b32 v4, 31, v2
    v_lshrrev_b32 v5, 5, v2
    s_mov_b32 s52, s40
    s_mov_b32 s53, s39
    s_cmp_eq_u32 s38, 0
    s_cselect_b32 s49, 1, 0
    s_cbranch_scc1 L_p_sel
    s_cmp_lg_u32 s40, 15
    s_cbranch_scc1 L_p_sel
    s_and_b32 s52, s39, 3
    s_lshl_b32 s52, s52, 2
    s_add_u32 s52, s52, s38
    s_sub_u32 s52, s52, 1
    s_lshr_b32 s53, s39, 2
    s_add_u32 s53, s53, 16
    s_cmp_lt_u32 s38, 5
    s_cselect_b32 s49, 1, 0
L_p_sel:
    s_cmp_eq_u32 s49, 0
    s_cbranch_scc1 L_pp_1
    s_mul_i32 s57, s52, 1600
    s_mul_i32 s55, s38, 10496
    s_cmp_eq_u32 s40, 15
    s_cselect_b32 s55, s55, 131072
    v_cmp_gt_u32 vcc, 36, v2
    v_mov_b32 v37, 2147483632
    v_and_b32 v36, 15, v2
    v_cndmask_b32 v32, v37, v3, vcc
    v_cmp_gt_u32 vcc, 15, v36
    v_mul_u32_u24 v38, 205, v36
    v_lshrrev_b32 v38, 10, v38
    v_mul_u32_u24 v38, 1200, v38
    v_lshl_add_u32 v36, v36, 4, v38
    v_lshrrev_b32 v38, 4, v2
    v_mul_u32_u24 v38, 3840, v38
    v_add_u32 v36, v36, v38
    v_cndmask_b32 v33, v37, v36, vcc
    s_mul_i32 s58, s53, 122880
    s_mul_i32 s56, s52, 80
    s_add_u32 s58, s58, s56
    v_lshlrev_b32 v34, 4, v5
    s_lshl_b32 s59, s53, 6
    s_waitcnt lgkmcnt(0)
    s_mov_b32 m0, s55
    s_nop 0
    buffer_load_dwordx4 v3, s[28:31], s57 offen lds
    buffer_load_dwordx4 v32, s[28:31], s57 offen offset:1024 lds
    s_add_u32 m0, s55, 2048
    s_nop 0
    buffer_load_dwordx4 v33, s[24:27], s58 offen lds
    s_add_u32 m0, s55, 3088
    s_add_u32 s58, s58, 15360
    buffer_load_dwordx4 v33, s[24:27], s58 offen lds
    s_add_u32 m0, s55, 4128
    s_add_u32 s58, s58, 15360
    buffer_load_dwordx4 v33, s[24:27], s58 offen lds
    s_add_u32 m0, s55, 5168
    s_add_u32 s58, s58, 15360
    buffer_load_dwordx4 v33, s[24:27], s58 offen lds
    s_add_u32 m0, s55, 6208
    s_add_u32 s58, s58, 15360
    buffer_load_dwordx4 v33, s[24:27], s58 offen lds
    s_add_u32 m0, s55, 7248
    s_add_u32 s58, s58, 15360
    buffer_load_dwordx4 v33, s[24:27], s58 offen lds
    s_add_u32 m0, s55, 8288
    s_add_u32 s58, s58, 15360
    buffer_load_dwordx4 v33, s[24:27], s58 offen lds
    s_add_u32 m0, s55, 9328
    s_add_u32 s58, s58, 15360
    buffer_load_dwordx4 v33, s[24:27], s58 offen lds
    buffer_load_dwordx4 v[160:163], v34, s[32:35], s59 offen
    buffer_load_dwordx4 v[164:167], v34, s[32:35], s59 offen offset:32
    s_barrier
L_pp_1:
    s_mov_b32 s10, 0x280000
    s_mov_b32 s11, 0x20000
    s_mov_b32 s14, 0x258000
    s_mov_b32 s15, 0x20000
    s_mov_b32 s18, 0x1a00000
    s_mov_b32 s19, 0x20000
    s_mov_b32 s22, 0x100
    s_mov_b32 s23, 0x20000
    s_lshr_b32 s54, s37, 3
    s_add_u32 s54, s54, s37
    s_and_b32 s54, s54, 3
    s_mov_b32 s98, 0x65832140
    s_mov_b32 s99, 0x97
    s_cmp_eq_u32 s54, 1
    s_cmov_b32 s98, 0x79403521
    s_cmov_b32 s99, 0x68
    s_cmp_eq_u32 s54, 2
    s_cmov_b32 s98, 0x57146032
    s_cmov_b32 s99, 0x89
    s_cmp_eq_u32 s54, 3
    s_cmov_b32 s98, 0x84571203
    s_cmov_b32 s99, 0x96
    s_mov_b64 s[100:101], s[98:99]
    s_and_b32 s46, s98, 15
    v_lshrrev_b32 v36, 3, v2
    s_lshl_b32 s54, s39, 7
    s_lshl_b32 s56, s38, 4
    s_add_u32 s54, s54, s56
    v_add_u32 v36, s54, v36
    v_mul_u32_u24 v36, 1280, v36
    v_lshrrev_b32 v37, 4, v2
    v_and_b32 v38, 7, v2
    v_xor_b32 v38, v38, v37
    v_lshlrev_b32 v38, 4, v38
    v_add_u32 v6, v36, v38
    v_xor_b32 v38, 64, v38
    v_add_u32 v7, v36, v38
    v_add_u32 v7, 10240, v7
    s_lshl_b32 s54, s38, 3
    v_add_u32 v36, s54, v37
    v_mul_u32_u24 v36, 3840, v36
    v_and_b32 v38, 15, v2
    v_lshlrev_b32 v37, 2, v37
    v_xor_b32 v38, v38, v37
    v_lshlrev_b32 v38, 4, v38
    v_add_u32 v36, v36, v38
    s_lshl_b32 s54, s40, 8
    v_add_u32 v8, s54, v36
    s_lshl_b32 s47, s38, 11
    s_mul_i32 s50, s40, 163840
    s_add_u32 s50, s50, s47
    s_add_u32 s50, s50, 7929856
    s_waitcnt lgkmcnt(0)
    s_mov_b32 s43, 0
    s_xor_b32 s60, s38, 1
    s_or_b32 s60, s2, s60
    s_cmp_lg_u32 s60, 0
    s_cbranch_scc1 L_np_2
    s_memrealtime s[60:61]
    v_mov_b32 v9, 0
    s_waitcnt lgkmcnt(0)
    s_or_b32 s60, s60, 1
    v_mov_b32 v1, s60
    s_mov_b64 exec, 1
    buffer_store_dword v1, v9, s[20:23], 0 offen sc0 sc1
    s_mov_b64 exec, -1
L_np_2:
    s_cmp_lg_u32 s49, 0
    s_cbranch_scc1 L_p_nb
    s_barrier
L_p_nb:
    s_cmp_eq_u32 s40, 15
    s_cbranch_scc1 L_p_nodma
    s_add_u32 m0, s47, 0
    s_lshl_b32 s44, s46, 7
    buffer_load_dwordx4 v6, s[8:11], s44 offen lds
    s_add_u32 m0, s47, 1024
    s_lshl_b32 s44, s46, 7
    buffer_load_dwordx4 v7, s[8:11], s44 offen lds
    s_add_u32 m0, s47, 16384
    s_mul_i32 s45, s46, 245760
    buffer_load_dwordx4 v8, s[12:15], s45 offen lds
    s_add_u32 m0, s47, 17408
    s_add_u32 s45, s45, 15360
    buffer_load_dwordx4 v8, s[12:15], s45 offen lds
    s_lshr_b64 s[98:99], s[98:99], 4
    s_and_b32 s46, s98, 15
L_p_nodma:
    s_cmp_lg_u32 s38, 2
    s_cbranch_scc1 L_cpf_done
    s_getpc_b64 s[60:61]
L_cpf_pc:
    s_lshl_b32 s62, s37, 11
    v_and_b32 v36, 15, v2
    v_lshlrev_b32 v36, 7, v36
    v_add_u32 v36, s62, v36
    v_min_u32 v36, L_end1-L_cpf_pc, v36
    global_load_dword v9, v36, s[60:61]
L_cpf_done:
    s_lshl_b32 s54, s41, 12
    v_lshlrev_b32 v36, 7, v4
    v_add_u32 v36, s54, v36
    v_bfe_u32 v37, v4, 1, 3
    v_xor_b32 v37, v37, v5
    v_xor_b32 v38, 0, v37
    v_lshl_add_u32 v10, v38, 4, v36
    v_add_u32 v14, 0x10000, v10
    v_xor_b32 v38, 2, v37
    v_lshl_add_u32 v11, v38, 4, v36
    v_add_u32 v15, 0x10000, v11
    v_xor_b32 v38, 4, v37
    v_lshl_add_u32 v12, v38, 4, v36
    v_add_u32 v16, 0x10000, v12
    v_xor_b32 v38, 6, v37
    v_lshl_add_u32 v13, v38, 4, v36
    v_add_u32 v17, 0x10000, v13
    v_bfe_u32 v36, v2, 2, 2
    v_lshl_add_u32 v37, v5, 3, v36
    v_lshlrev_b32 v37, 8, v37
    v_add_u32 v37, 16384, v37
    v_and_b32 v38, 1, v2
    v_bfe_u32 v1, v2, 1, 1
    s_cmp_ge_u32 s40, 10
    s_cselect_b64 vcc, -1, 0
    v_cndmask_b32 v0, v1, v38, vcc
    v_cndmask_b32 v1, v38, v1, vcc
    v_lshl_add_u32 v37, v0, 3, v37
    v_bfe_u32 v38, v2, 4, 1
    v_lshl_add_u32 v38, v38, 1, v1
    s_lshl_b32 s54, s42, 3
    v_add_u32 v38, s54, v38
    v_lshlrev_b32 v36, 2, v36
    v_xor_b32 v38, v38, v36
    v_lshl_add_u32 v18, v38, 4, v37
    v_xor_b32 v38, 4, v38
    v_lshl_add_u32 v19, v38, 4, v37
    v_add_u32 v20, 0x10000, v18
    v_add_u32 v21, 0x10000, v19
    s_lshl_b32 s54, s42, 11
    s_add_u32 s54, s54, 65536
    v_add_u32 v22, s54, v3
    v_add_u32 v23, 0x10000, v22
    s_lshl_b32 s48, s39, 2
    s_add_u32 s48, s48, s41
    s_cmp_eq_u32 s40, 15
    s_cbranch_scc1 L_p1_x
    s_cmp_eq_u32 s49, 0
    s_cbranch_scc1 L_pp_3
    v_bfe_u32 v36, v2, 2, 2
    v_lshl_add_u32 v36, v5, 3, v36
    v_and_b32 v37, 1, v2
    v_mul_u32_u24 v37, 20, v37
    v_sub_u32 v38, v36, v37
    v_bfe_u32 v39, v2, 1, 1
    v_bfe_u32 v1, v2, 4, 1
    v_lshl_add_u32 v39, v1, 1, v39
    v_mul_u32_u24 v36, 40, v36
    v_add_u32 v36, s55, v36
    v_lshl_add_u32 v0, v39, 3, v36
    v_cmp_eq_u32 s[58:59], 0, v39
    s_add_u32 s57, s55, 1600
    v_mov_b32 v37, s57
    s_waitcnt vmcnt(14)
    v_add_u32 v1, 0, v38
    v_cmp_gt_u32 vcc, 20, v1
    v_add_u32 v1, 0, v0
    v_add_u32 v39, 32, v36
    v_cndmask_b32 v1, v37, v1, vcc
    s_and_b64 vcc, vcc, s[58:59]
    ds_read_b64_tr_b16 v[168:169], v1
    v_cndmask_b32 v39, v37, v39, vcc
    ds_read_b64_tr_b16 v[180:181], v39
    v_add_u32 v1, 4, v38
    v_cmp_gt_u32 vcc, 20, v1
    v_add_u32 v1, 160, v0
    v_add_u32 v39, 192, v36
    v_cndmask_b32 v1, v37, v1, vcc
    s_and_b64 vcc, vcc, s[58:59]
    ds_read_b64_tr_b16 v[170:171], v1
    v_cndmask_b32 v39, v37, v39, vcc
    ds_read_b64_tr_b16 v[182:183], v39
    v_add_u32 v1, 16, v38
    v_cmp_gt_u32 vcc, 20, v1
    v_add_u32 v1, 640, v0
    v_add_u32 v39, 672, v36
    v_cndmask_b32 v1, v37, v1, vcc
    s_and_b64 vcc, vcc, s[58:59]
    ds_read_b64_tr_b16 v[172:173], v1
    v_cndmask_b32 v39, v37, v39, vcc
    ds_read_b64_tr_b16 v[184:185], v39
    v_add_u32 v1, 20, v38
    v_cmp_gt_u32 vcc, 20, v1
    v_add_u32 v1, 800, v0
    v_add_u32 v39, 832, v36
    v_cndmask_b32 v1, v37, v1, vcc
    s_and_b64 vcc, vcc, s[58:59]
    ds_read_b64_tr_b16 v[174:175], v1
    v_cndmask_b32 v39, v37, v39, vcc
    ds_read_b64_tr_b16 v[186:187], v39
    v_add_u32 v1, 32, v38
    v_cmp_gt_u32 vcc, 20, v1
    v_add_u32 v1, 1280, v0
    v_add_u32 v39, 1312, v36
    v_cndmask_b32 v1, v37, v1, vcc
    s_and_b64 vcc, vcc, s[58:59]
    ds_read_b64_tr_b16 v[176:177], v1
    v_cndmask_b32 v39, v37, v39, vcc
    ds_read_b64_tr_b16 v[188:189], v39
    v_add_u32 v1, 36, v38
    v_cmp_gt_u32 vcc, 20, v1
    v_add_u32 v1, 1440, v0
    v_add_u32 v39, 1472, v36
    v_cndmask_b32 v1, v37, v1, vcc
    s_and_b64 vcc, vcc, s[58:59]
    ds_read_b64_tr_b16 v[178:179], v1
    v_cndmask_b32 v39, v37, v39, vcc
    ds_read_b64_tr_b16 v[190:191], v39
    v_and_b32 v0, 3, v4
    v_lshlrev_b32 v0, 4, v0
    v_mov_b32 v36, 0x3f80
    v_mov_b32 v37, 0
    v_lshlrev_b64 v[36:37], v0, v[36:37]
    v_bfe_u32 v0, v4, 2, 1
    v_mul_u32_u24 v0, 5, v0
    v_lshrrev_b32 v1, 3, v4
    v_add_u32 v0, v0, v1
    v_lshlrev_b32 v38, 1, v5
    v_sub_u32 v0, v0, v38
    v_cmp_eq_u32 vcc, 0, v1
    v_mov_b32 v38, 99
    s_nop 0
    v_cndmask_b32 v0, v0, v38, vcc
    v_cmp_eq_u32 s[58:59], 3, v1
    v_cmp_eq_u32 vcc, 1, v0
    s_nop 1
    v_cndmask_b32 v192, 0, v36, vcc
    v_cndmask_b32 v193, 0, v37, vcc
    v_cmp_eq_u32 vcc, -2, v0
    s_nop 1
    v_cndmask_b32 v204, 0, v36, vcc
    v_cndmask_b32 v205, 0, v37, vcc
    v_cmp_eq_u32 vcc, 2, v0
    s_nop 1
    v_cndmask_b32 v194, 0, v36, vcc
    v_cndmask_b32 v195, 0, v37, vcc
    v_cmp_eq_u32 vcc, -1, v0
    s_nop 1
    v_cndmask_b32 v206, 0, v36, vcc
    v_cndmask_b32 v207, 0, v37, vcc
    v_cmp_eq_u32 vcc, 5, v0
    s_nop 1
    v_cndmask_b32 v196, 0, v36, vcc
    v_cndmask_b32 v197, 0, v37, vcc
    v_cmp_eq_u32 vcc, 2, v0
    s_nop 1
    v_cndmask_b32 v208, 0, v36, vcc
    v_cndmask_b32 v209, 0, v37, vcc
    v_cmp_eq_u32 vcc, 6, v0
    s_nop 1
    v_cndmask_b32 v198, 0, v36, vcc
    v_cndmask_b32 v199, 0, v37, vcc
    v_cmp_eq_u32 vcc, 3, v0
    s_nop 1
    v_cndmask_b32 v210, 0, v36, vcc
    v_cndmask_b32 v211, 0, v37, vcc
    v_cmp_eq_u32 vcc, 9, v0
    s_nop 1
    v_cndmask_b32 v200, 0, v36, vcc
    v_cndmask_b32 v201, 0, v37, vcc
    v_cmp_eq_u32 vcc, 6, v0
    s_nop 1
    v_cndmask_b32 v212, 0, v36, vcc
    v_cndmask_b32 v213, 0, v37, vcc
    v_cmp_eq_u32 vcc, 10, v0
    s_nop 1
    v_cndmask_b32 v202, 0, v36, vcc
    v_cndmask_b32 v203, 0, v37, vcc
    v_cmp_eq_u32 vcc, 7, v0
    s_nop 1
    v_cndmask_b32 v214, 0, v36, vcc
    v_cndmask_b32 v215, 0, v37, vcc
    s_mul_i32 s54, s52, 163840
    s_lshl_b32 s56, s53, 13
    s_add_u32 s54, s54, s56
    s_add_u32 s54, s54, 7929856
    s_add_u32 s56, s54, 4096
    v_and_b32 v36, 0x13, v4
    v_bfe_u32 v38, v4, 2, 1
    v_lshl_or_b32 v36, v38, 3, v36
    v_bfe_u32 v38, v4, 3, 1
    v_lshl_or_b32 v36, v38, 2, v36
    v_lshrrev_b32 v37, 2, v36
    v_mul_u32_u24 v37, 1040, v37
    v_and_b32 v36, 3, v36
    v_lshl_add_u32 v36, v36, 8, v37
    v_lshl_add_u32 v36, v5, 4, v36
    v_add_u32 v36, s55, v36
    s_waitcnt vmcnt(4)
    ds_read_b128 v[124:127], v36 offset:2048
    ds_read_b128 v[128:131], v36 offset:2080
    ds_read_b128 v[132:135], v36 offset:2112
    ds_read_b128 v[136:139], v36 offset:2128
    ds_read_b128 v[140:143], v36 offset:2160
    ds_read_b128 v[144:147], v36 offset:2192
    ds_read_b128 v[148:151], v36 offset:2208
    ds_read_b128 v[152:155], v36 offset:2240
    ds_read_b128 v[156:159], v36 offset:2272
    s_waitcnt lgkmcnt(0)
    v_mfma_f32_32x32x16_bf16 v[216:231], v[124:127], v[168:171], 0
    v_mfma_f32_32x32x16_bf16 v[216:231], v[128:131], v[172:175], v[216:231]
    v_mfma_f32_32x32x16_bf16 v[216:231], v[132:135], v[176:179], v[216:231]
    v_mfma_f32_32x32x16_bf16 v[232:247], v[124:127], v[180:183], 0
    v_mfma_f32_32x32x16_bf16 v[232:247], v[128:131], v[184:187], v[232:247]
    v_mfma_f32_32x32x16_bf16 v[232:247], v[132:135], v[188:191], v[232:247]
    v_mfma_f32_32x32x16_bf16 v[232:247], v[148:151], v[192:195], v[232:247]
    v_mfma_f32_32x32x16_bf16 v[232:247], v[152:155], v[196:199], v[232:247]
    v_mfma_f32_32x32x16_bf16 v[232:247], v[156:159], v[200:203], v[232:247]
    s_add_u32 m0, s47, 32768
    s_lshl_b32 s44, s46, 7
    buffer_load_dwordx4 v6, s[8:11], s44 offen lds
    s_add_u32 m0, s47, 33792
    s_lshl_b32 s44, s46, 7
    buffer_load_dwordx4 v7, s[8:11], s44 offen lds
    s_add_u32 m0, s47, 49152
    s_mul_i32 s45, s46, 245760
    buffer_load_dwordx4 v8, s[12:15], s45 offen lds
    s_add_u32 m0, s47, 50176
    s_add_u32 s45, s45, 15360
    buffer_load_dwordx4 v8, s[12:15], s45 offen lds
    s_lshr_b64 s[98:99], s[98:99], 4
    s_and_b32 s46, s98, 15
    v_cvt_pk_bf16_f32 v216, v216, v217
    v_cvt_pk_bf16_f32 v217, v218, v219
    v_cvt_pk_bf16_f32 v218, v220, v221
    v_cvt_pk_bf16_f32 v219, v222, v223
    v_cvt_pk_bf16_f32 v224, v224, v225
    v_cvt_pk_bf16_f32 v225, v226, v227
    v_cvt_pk_bf16_f32 v226, v228, v229
    v_cvt_pk_bf16_f32 v227, v230, v231
    buffer_store_dwordx4 v[216:219], v3, s[16:19], s54 offen offset:0 sc1
    buffer_store_dwordx4 v[224:227], v3, s[16:19], s56 offen offset:0 sc1
    s_nop 1
    v_mfma_f32_32x32x16_bf16 v[216:231], v[136:139], v[168:171], 0
    v_mfma_f32_32x32x16_bf16 v[216:231], v[140:143], v[172:175], v[216:231]
    v_mfma_f32_32x32x16_bf16 v[216:231], v[144:147], v[176:179], v[216:231]
    v_cvt_pk_bf16_f32 v232, v232, v233
    v_cvt_pk_bf16_f32 v233, v234, v235
    v_cvt_pk_bf16_f32 v234, v236, v237
    v_cvt_pk_bf16_f32 v235, v238, v239
    v_cvt_pk_bf16_f32 v240, v240, v241
    v_cvt_pk_bf16_f32 v241, v242, v243
    v_cvt_pk_bf16_f32 v242, v244, v245
    v_cvt_pk_bf16_f32 v243, v246, v247
    buffer_store_dwordx4 v[232:235], v3, s[16:19], s54 offen offset:1024 sc1
    buffer_store_dwordx4 v[240:243], v3, s[16:19], s56 offen offset:1024 sc1
    s_nop 1
    v_mfma_f32_32x32x16_bf16 v[232:247], v[136:139], v[180:183], 0
    v_mfma_f32_32x32x16_bf16 v[232:247], v[140:143], v[184:187], v[232:247]
    v_mfma_f32_32x32x16_bf16 v[232:247], v[144:147], v[188:191], v[232:247]
    v_mfma_f32_32x32x16_bf16 v[232:247], v[148:151], v[204:207], v[232:247]
    v_mfma_f32_32x32x16_bf16 v[232:247], v[152:155], v[208:211], v[232:247]
    v_mfma_f32_32x32x16_bf16 v[232:247], v[156:159], v[212:215], v[232:247]
    v_cvt_pk_bf16_f32 v216, v216, v217
    v_cvt_pk_bf16_f32 v217, v218, v219
    v_cvt_pk_bf16_f32 v218, v220, v221
    v_cvt_pk_bf16_f32 v219, v222, v223
    v_cvt_pk_bf16_f32 v224, v224, v225
    v_cvt_pk_bf16_f32 v225, v226, v227
    v_cvt_pk_bf16_f32 v226, v228, v229
    v_cvt_pk_bf16_f32 v227, v230, v231
    buffer_store_dwordx4 v[216:219], v3, s[16:19], s54 offen offset:2048 sc1
    buffer_store_dwordx4 v[224:227], v3, s[16:19], s56 offen offset:2048 sc1
    s_nop 3
    v_cvt_pk_bf16_f32 v232, v232, v233
    v_cvt_pk_bf16_f32 v233, v234, v235
    v_cvt_pk_bf16_f32 v234, v236, v237
    v_cvt_pk_bf16_f32 v235, v238, v239
    v_cndmask_b32 v232, v232, v160, s[58:59]
    v_cndmask_b32 v233, v233, v161, s[58:59]
    v_cndmask_b32 v234, v234, v162, s[58:59]
    v_cndmask_b32 v235, v235, v163, s[58:59]
    v_cvt_pk_bf16_f32 v240, v240, v241
    v_cvt_pk_bf16_f32 v241, v242, v243
    v_cvt_pk_bf16_f32 v242, v244, v245
    v_cvt_pk_bf16_f32 v243, v246, v247
    v_cndmask_b32 v240, v240, v164, s[58:59]
    v_cndmask_b32 v241, v241, v165, s[58:59]
    v_cndmask_b32 v242, v242, v166, s[58:59]
    v_cndmask_b32 v243, v243, v167, s[58:59]
    buffer_store_dwordx4 v[232:235], v3, s[16:19], s54 offen offset:3072 sc1
    buffer_store_dwordx4 v[240:243], v3, s[16:19], s56 offen offset:3072 sc1
    s_cmp_lg_u32 s53, 0
    s_cbranch_scc1 L_nz_4
    s_lshl_b32 s54, s52, 13
    s_add_u32 s54, s54, 10551296
    s_add_u32 s56, s54, 4096
    v_mov_b32 v124, 0
    v_mov_b32 v125, 0
    v_mov_b32 v126, 0
    v_mov_b32 v127, 0
    buffer_store_dwordx4 v[124:127], v3, s[16:19], s54 offen offset:0 sc1
    buffer_store_dwordx4 v[124:127], v3, s[16:19], s56 offen offset:0 sc1
    buffer_store_dwordx4 v[124:127], v3, s[16:19], s54 offen offset:1024 sc1
    buffer_store_dwordx4 v[124:127], v3, s[16:19], s56 offen offset:1024 sc1
    buffer_store_dwordx4 v[124:127], v3, s[16:19], s54 offen offset:2048 sc1
    buffer_store_dwordx4 v[124:127], v3, s[16:19], s56 offen offset:2048 sc1
    buffer_store_dwordx4 v[124:127], v3, s[16:19], s54 offen offset:3072 sc1
    buffer_store_dwordx4 v[124:127], v3, s[16:19], s56 offen offset:3072 sc1
L_nz_4:
L_pp_3:
    s_cmp_ge_u32 s40, 10
    s_cbranch_scc1 L_p1_v
    s_cmp_ge_u32 s40, 5
    s_cselect_b32 s54, 5, 0
    s_sub_u32 s54, s40, s54
    s_lshl_b32 s54, s54, 4
    s_lshl_b32 s56, s42, 3
    s_add_u32 s54, s54, s56
    s_cmp_ge_u32 s40, 5
    s_mov_b32 s56, 81920
    s_cselect_b32 s58, 163840, s56
    s_mov_b32 s56, 1280
    s_cselect_b32 s59, 2560, s56
    s_mov_b32 s56, 0
    s_cselect_b32 s63, 2621440, s56
    s_mov_b32 s56, 0x3ea52b5c
    s_cselect_b32 s64, 1.0, s56
    s_mul_i32 s59, s59, s48
    s_add_u32 s63, s63, s59
    s_lshl_b32 s59, s58, 1
    s_sub_u32 s65, s58, 1536
    v_mov_b32 v36, v4
    v_add_u32 v38, s54, v5
    v_bfe_u32 v0, v4, 2, 1
    v_mul_u32_u24 v1, 3, v0
    v_xor_b32 v1, v1, v4
    v_and_b32 v1, 3, v1
    v_lshlrev_b32 v1, 4, v1
    v_lshrrev_b32 v39, 3, v4
    v_lshl_add_u32 v39, v39, 6, v1
    v_mul_lo_u32 v0, v0, s58
    v_add_u32 v39, v39, v0
    v_add_u32 v39, 1024, v39
    v_add_u32 v0, 0, v38
    v_mul_u32_u24 v1, 205, v0
    v_lshrrev_b32 v1, 10, v1
    v_mul_u32_u24 v37, 5, v1
    v_sub_u32 v0, v0, v37
    v_mul_lo_u32 v1, v1, s59
    v_add_u32 v1, s63, v1
    v_cmp_lt_u32 vcc, 2, v0
    v_lshl_add_u32 v37, v0, 9, v1
    v_lshl_add_u32 v37, v36, 4, v37
    v_add_u32 v24, s65, v37
    v_cndmask_b32 v37, v37, v24, vcc
    v_cmp_eq_u32 s[4:5], 2, v0
    v_add_u32 v1, v1, v39
    s_nop 0
    v_cndmask_b32 v24, v37, v1, s[4:5]
    v_add_u32 v0, 2, v38
    v_mul_u32_u24 v1, 205, v0
    v_lshrrev_b32 v1, 10, v1
    v_mul_u32_u24 v37, 5, v1
    v_sub_u32 v0, v0, v37
    v_mul_lo_u32 v1, v1, s59
    v_add_u32 v1, s63, v1
    v_cmp_lt_u32 vcc, 2, v0
    v_lshl_add_u32 v37, v0, 9, v1
    v_lshl_add_u32 v37, v36, 4, v37
    v_add_u32 v25, s65, v37
    v_cndmask_b32 v37, v37, v25, vcc
    v_cmp_eq_u32 s[6:7], 2, v0
    v_add_u32 v1, v1, v39
    s_nop 0
    v_cndmask_b32 v25, v37, v1, s[6:7]
    v_add_u32 v0, 4, v38
    v_mul_u32_u24 v1, 205, v0
    v_lshrrev_b32 v1, 10, v1
    v_mul_u32_u24 v37, 5, v1
    v_sub_u32 v0, v0, v37
    v_mul_lo_u32 v1, v1, s59
    v_add_u32 v1, s63, v1
    v_cmp_lt_u32 vcc, 2, v0
    v_lshl_add_u32 v37, v0, 9, v1
    v_lshl_add_u32 v37, v36, 4, v37
    v_add_u32 v26, s65, v37
    v_cndmask_b32 v37, v37, v26, vcc
    v_cmp_eq_u32 s[74:75], 2, v0
    v_add_u32 v1, v1, v39
    s_nop 0
    v_cndmask_b32 v26, v37, v1, s[74:75]
    v_add_u32 v0, 6, v38
    v_mul_u32_u24 v1, 205, v0
    v_lshrrev_b32 v1, 10, v1
    v_mul_u32_u24 v37, 5, v1
    v_sub_u32 v0, v0, v37
    v_mul_lo_u32 v1, v1, s59
    v_add_u32 v1, s63, v1
    v_cmp_lt_u32 vcc, 2, v0
    v_lshl_add_u32 v37, v0, 9, v1
    v_lshl_add_u32 v37, v36, 4, v37
    v_add_u32 v27, s65, v37
    v_cndmask_b32 v37, v37, v27, vcc
    v_cmp_eq_u32 s[76:77], 2, v0
    v_add_u32 v1, v1, v39
    s_nop 0
    v_cndmask_b32 v27, v37, v1, s[76:77]
    s_cmp_lg_u32 s49, 0
    s_cbranch_scc1 L_pc_5
    s_waitcnt vmcnt(2)
    s_add_u32 m0, s47, 32768
    s_lshl_b32 s44, s46, 7
    buffer_load_dwordx4 v6, s[8:11], s44 offen lds
    s_add_u32 m0, s47, 33792
    s_lshl_b32 s44, s46, 7
    buffer_load_dwordx4 v7, s[8:11], s44 offen lds
    s_waitcnt vmcnt(2)
    s_add_u32 m0, s47, 49152
    s_mul_i32 s45, s46, 245760
    buffer_load_dwordx4 v8, s[12:15], s45 offen lds
    s_add_u32 m0, s47, 50176
    s_add_u32 s45, s45, 15360
    buffer_load_dwordx4 v8, s[12:15], s45 offen lds
    s_lshr_b64 s[98:99], s[98:99], 4
    s_and_b32 s46, s98, 15
    s_waitcnt vmcnt(4)
    s_branch L_pc_6
L_pc_5:
    s_waitcnt vmcnt(12)
L_pc_6:
    v_mov_b32 v0, 0
    buffer_load_dword v35, v0, s[20:23], 0 offen sc0 sc1
    s_barrier
    ds_read_b128 v[88:91], v10 offset:0
    ds_read_b64_tr_b16 v[40:41], v18 offset:0
    ds_read_b64_tr_b16 v[42:43], v18 offset:1024
    ds_read_b64_tr_b16 v[44:45], v19 offset:0
    ds_read_b64_tr_b16 v[46:47], v19 offset:1024
    ds_read_b128 v[92:95], v11 offset:0
    ds_read_b64_tr_b16 v[48:49], v18 offset:4096
    ds_read_b64_tr_b16 v[50:51], v18 offset:5120
    ds_read_b64_tr_b16 v[52:53], v19 offset:4096
    ds_read_b64_tr_b16 v[54:55], v19 offset:5120
    ds_read_b128 v[96:99], v12 offset:0
    ds_read_b64_tr_b16 v[248:249], v18 offset:8192
    ds_read_b64_tr_b16 v[250:251], v18 offset:9216
    ds_read_b64_tr_b16 v[252:253], v19 offset:8192
    ds_read_b64_tr_b16 v[254:255], v19 offset:9216
    s_waitcnt lgkmcnt(10)
    v_mfma_f32_32x32x16_bf16 v[56:71], v[40:43], v[88:91], 0
    v_mfma_f32_32x32x16_bf16 v[72:87], v[44:47], v[88:91], 0
    s_add_u32 m0, s47, 65536
    s_lshl_b32 s44, s46, 7
    buffer_load_dwordx4 v6, s[8:11], s44 offen lds
    s_add_u32 m0, s47, 66560
    s_lshl_b32 s44, s46, 7
    buffer_load_dwordx4 v7, s[8:11], s44 offen lds
    ds_read_b128 v[100:103], v13 offset:0
    ds_read_b64_tr_b16 v[40:41], v18 offset:12288
    ds_read_b64_tr_b16 v[42:43], v18 offset:13312
    ds_read_b64_tr_b16 v[44:45], v19 offset:12288
    ds_read_b64_tr_b16 v[46:47], v19 offset:13312
    s_waitcnt lgkmcnt(10)
    v_mfma_f32_32x32x16_bf16 v[56:71], v[48:51], v[92:95], v[56:71]
    v_mfma_f32_32x32x16_bf16 v[72:87], v[52:55], v[92:95], v[72:87]
    s_add_u32 m0, s47, 81920
    s_mul_i32 s45, s46, 245760
    buffer_load_dwordx4 v8, s[12:15], s45 offen lds
    s_add_u32 m0, s47, 82944
    s_add_u32 s45, s45, 15360
    buffer_load_dwordx4 v8, s[12:15], s45 offen lds
    s_lshr_b64 s[98:99], s[98:99], 4
    s_and_b32 s46, s98, 15
    s_cmp_eq_u32 s49, 0
    s_cbranch_scc1 L_es_7
    s_waitcnt vmcnt(13)
    s_branch L_es_8
L_es_7:
    s_waitcnt vmcnt(5)
L_es_8:
    s_barrier
    ds_read_b128 v[104:107], v10 offset:32768
    ds_read_b64_tr_b16 v[48:49], v18 offset:32768
    ds_read_b64_tr_b16 v[50:51], v18 offset:33792
    ds_read_b64_tr_b16 v[52:53], v19 offset:32768
    ds_read_b64_tr_b16 v[54:55], v19 offset:33792
    s_waitcnt lgkmcnt(10)
    v_mfma_f32_32x32x16_bf16 v[56:71], v[248:251], v[96:99], v[56:71]
    v_mfma_f32_32x32x16_bf16 v[72:87], v[252:255], v[96:99], v[72:87]
    s_add_u32 m0, s47, 98304
    s_lshl_b32 s44, s46, 7
    buffer_load_dwordx4 v6, s[8:11], s44 offen lds
    ds_read_b128 v[108:111], v11 offset:32768
    ds_read_b64_tr_b16 v[248:249], v18 offset:36864
    ds_read_b64_tr_b16 v[250:251], v18 offset:37888
    ds_read_b64_tr_b16 v[252:253], v19 offset:36864
    ds_read_b64_tr_b16 v[254:255], v19 offset:37888
    s_waitcnt lgkmcnt(10)
    v_mfma_f32_32x32x16_bf16 v[56:71], v[40:43], v[100:103], v[56:71]
    v_mfma_f32_32x32x16_bf16 v[72:87], v[44:47], v[100:103], v[72:87]
    s_add_u32 m0, s47, 99328
    s_lshl_b32 s44, s46, 7
    buffer_load_dwordx4 v7, s[8:11], s44 offen lds
    ds_read_b128 v[112:115], v12 offset:32768
    ds_read_b64_tr_b16 v[40:41], v18 offset:40960
    ds_read_b64_tr_b16 v[42:43], v18 offset:41984
    ds_read_b64_tr_b16 v[44:45], v19 offset:40960
    ds_read_b64_tr_b16 v[46:47], v19 offset:41984
    s_waitcnt lgkmcnt(10)
    v_mfma_f32_32x32x16_bf16 v[56:71], v[48:51], v[104:107], v[56:71]
    v_mfma_f32_32x32x16_bf16 v[72:87], v[52:55], v[104:107], v[72:87]
    s_add_u32 m0, s47, 114688
    s_mul_i32 s45, s46, 245760
    buffer_load_dwordx4 v8, s[12:15], s45 offen lds
    ds_read_b128 v[116:119], v13 offset:32768
    ds_read_b64_tr_b16 v[48:49], v18 offset:45056
    ds_read_b64_tr_b16 v[50:51], v18 offset:46080
    ds_read_b64_tr_b16 v[52:53], v19 offset:45056
    ds_read_b64_tr_b16 v[54:55], v19 offset:46080
    s_waitcnt lgkmcnt(10)
    v_mfma_f32_32x32x16_bf16 v[56:71], v[248:251], v[108:111], v[56:71]
    v_mfma_f32_32x32x16_bf16 v[72:87], v[252:255], v[108:111], v[72:87]
    s_add_u32 m0, s47, 115712
    s_add_u32 s45, s45, 15360
    buffer_load_dwordx4 v8, s[12:15], s45 offen lds
    s_lshr_b64 s[98:99], s[98:99], 4
    s_and_b32 s46, s98, 15
    s_waitcnt vmcnt(4)
    s_barrier
    ds_read_b128 v[120:123], v14 offset:0
    ds_read_b64_tr_b16 v[248:249], v20 offset:0
    ds_read_b64_tr_b16 v[250:251], v20 offset:1024
    ds_read_b64_tr_b16 v[252:253], v21 offset:0
    ds_read_b64_tr_b16 v[254:255], v21 offset:1024
    v_readfirstlane_b32 s60, v35
    s_max_u32 s43, s43, s60
    s_cmp_eq_u32 s49, 0
    s_cbranch_scc1 L_pa_9
    s_cmp_lg_u32 s43, 0
    s_cbranch_scc1 L_ngd_11
    v_mov_b32 v0, 0
    s_mov_b32 s62, 0x200000
L_ng_10:
    buffer_load_dword v1, v0, s[20:23], 0 offen sc0 sc1
    s_waitcnt vmcnt(0)
    v_readfirstlane_b32 s43, v1
    s_cmp_lg_u32 s43, 0
    s_cbranch_scc1 L_ngd_11
    s_sleep 8
    s_sub_u32 s62, s62, 1
    s_cmp_lg_u32 s62, 0
    s_cbranch_scc1 L_ng_10
L_ngd_11:
    s_lshl_b32 s60, s52, 5
    s_add_u32 s60, s60, s53
    s_lshl_b32 s60, s60, 4
    s_add_u32 s60, s60, 10698752
    v_mov_b32 v0, 0
    v_mov_b32 v1, s43
    s_mov_b64 exec, 1
    buffer_store_dword v1, v0, s[16:19], s60 offen sc0 sc1
    s_mov_b64 exec, -1
L_pa_9:
    s_waitcnt lgkmcnt(10)
    v_mfma_f32_32x32x16_bf16 v[56:71], v[40:43], v[112:115], v[56:71]
    v_mfma_f32_32x32x16_bf16 v[72:87], v[44:47], v[112:115], v[72:87]
    s_add_u32 m0, s47, 0
    s_lshl_b32 s44, s46, 7
    buffer_load_dwordx4 v6, s[8:11], s44 offen lds
    ds_read_b128 v[124:127], v15 offset:0
    ds_read_b64_tr_b16 v[40:41], v20 offset:4096
    ds_read_b64_tr_b16 v[42:43], v20 offset:5120
    ds_read_b64_tr_b16 v[44:45], v21 offset:4096
    ds_read_b64_tr_b16 v[46:47], v21 offset:5120
    s_waitcnt lgkmcnt(10)
    v_mfma_f32_32x32x16_bf16 v[56:71], v[48:51], v[116:119], v[56:71]
    v_mfma_f32_32x32x16_bf16 v[72:87], v[52:55], v[116:119], v[72:87]
    s_add_u32 m0, s47, 1024
    s_lshl_b32 s44, s46, 7
    buffer_load_dwordx4 v7, s[8:11], s44 offen lds
    ds_read_b128 v[128:131], v16 offset:0
    ds_read_b64_tr_b16 v[48:49], v20 offset:8192
    ds_read_b64_tr_b16 v[50:51], v20 offset:9216
    ds_read_b64_tr_b16 v[52:53], v21 offset:8192
    ds_read_b64_tr_b16 v[54:55], v21 offset:9216
    s_waitcnt lgkmcnt(10)
    v_mfma_f32_32x32x16_bf16 v[56:71], v[248:251], v[120:123], v[56:71]
    v_mfma_f32_32x32x16_bf16 v[72:87], v[252:255], v[120:123], v[72:87]
    s_add_u32 m0, s47, 16384
    s_mul_i32 s45, s46, 245760
    buffer_load_dwordx4 v8, s[12:15], s45 offen lds
    ds_read_b128 v[132:135], v17 offset:0
    ds_read_b64_tr_b16 v[248:249], v20 offset:12288
    ds_read_b64_tr_b16 v[250:251], v20 offset:13312
    ds_read_b64_tr_b16 v[252:253], v21 offset:12288
    ds_read_b64_tr_b16 v[254:255], v21 offset:13312
    s_waitcnt lgkmcnt(10)
    v_mfma_f32_32x32x16_bf16 v[56:71], v[40:43], v[124:127], v[56:71]
    v_mfma_f32_32x32x16_bf16 v[72:87], v[44:47], v[124:127], v[72:87]
    s_add_u32 m0, s47, 17408
    s_add_u32 s45, s45, 15360
    buffer_load_dwordx4 v8, s[12:15], s45 offen lds
    s_lshr_b64 s[98:99], s[98:99], 4
    s_and_b32 s46, s98, 15
    s_cmp_eq_u32 s49, 0
    s_cbranch_scc1 L_es_12
    s_waitcnt vmcnt(5)
    s_branch L_es_13
L_es_12:
    s_waitcnt vmcnt(4)
L_es_13:
    s_barrier
    ds_read_b128 v[136:139], v14 offset:32768
    ds_read_b64_tr_b16 v[40:41], v20 offset:32768
    ds_read_b64_tr_b16 v[42:43], v20 offset:33792
    ds_read_b64_tr_b16 v[44:45], v21 offset:32768
    ds_read_b64_tr_b16 v[46:47], v21 offset:33792
    s_waitcnt lgkmcnt(10)
    v_mfma_f32_32x32x16_bf16 v[56:71], v[48:51], v[128:131], v[56:71]
    v_mfma_f32_32x32x16_bf16 v[72:87], v[52:55], v[128:131], v[72:87]
    s_add_u32 m0, s47, 32768
    s_lshl_b32 s44, s46, 7
    buffer_load_dwordx4 v6, s[8:11], s44 offen lds
    ds_read_b128 v[140:143], v15 offset:32768
    ds_read_b64_tr_b16 v[48:49], v20 offset:36864
    ds_read_b64_tr_b16 v[50:51], v20 offset:37888
    ds_read_b64_tr_b16 v[52:53], v21 offset:36864
    ds_read_b64_tr_b16 v[54:55], v21 offset:37888
    s_waitcnt lgkmcnt(10)
    v_mfma_f32_32x32x16_bf16 v[56:71], v[248:251], v[132:135], v[56:71]
    v_mfma_f32_32x32x16_bf16 v[72:87], v[252:255], v[132:135], v[72:87]
    s_add_u32 m0, s47, 33792
    s_lshl_b32 s44, s46, 7
    buffer_load_dwordx4 v7, s[8:11], s44 offen lds
    ds_read_b128 v[144:147], v16 offset:32768
    ds_read_b64_tr_b16 v[248:249], v20 offset:40960
    ds_read_b64_tr_b16 v[250:251], v20 offset:41984
    ds_read_b64_tr_b16 v[252:253], v21 offset:40960
    ds_read_b64_tr_b16 v[254:255], v21 offset:41984
    s_waitcnt lgkmcnt(10)
    v_mfma_f32_32x32x16_bf16 v[56:71], v[40:43], v[136:139], v[56:71]
    v_mfma_f32_32x32x16_bf16 v[72:87], v[44:47], v[136:139], v[72:87]
    s_add_u32 m0, s47, 49152
    s_mul_i32 s45, s46, 245760
    buffer_load_dwordx4 v8, s[12:15], s45 offen lds
    ds_read_b128 v[148:151], v17 offset:32768
    ds_read_b64_tr_b16 v[40:41], v20 offset:45056
    ds_read_b64_tr_b16 v[42:43], v20 offset:46080
    ds_read_b64_tr_b16 v[44:45], v21 offset:45056
    ds_read_b64_tr_b16 v[46:47], v21 offset:46080
    s_waitcnt lgkmcnt(10)
    v_mfma_f32_32x32x16_bf16 v[56:71], v[48:51], v[140:143], v[56:71]
    v_mfma_f32_32x32x16_bf16 v[72:87], v[52:55], v[140:143], v[72:87]
    s_add_u32 m0, s47, 50176
    s_add_u32 s45, s45, 15360
    buffer_load_dwordx4 v8, s[12:15], s45 offen lds
    s_lshr_b64 s[98:99], s[98:99], 4
    s_and_b32 s46, s98, 15
    s_waitcnt vmcnt(4)
    s_barrier
    ds_read_b128 v[152:155], v10 offset:0
    ds_read_b64_tr_b16 v[48:49], v18 offset:0
    ds_read_b64_tr_b16 v[50:51], v18 offset:1024
    ds_read_b64_tr_b16 v[52:53], v19 offset:0
    ds_read_b64_tr_b16 v[54:55], v19 offset:1024
    s_waitcnt lgkmcnt(10)
    v_mfma_f32_32x32x16_bf16 v[56:71], v[248:251], v[144:147], v[56:71]
    v_mfma_f32_32x32x16_bf16 v[72:87], v[252:255], v[144:147], v[72:87]
    s_add_u32 m0, s47, 65536
    s_lshl_b32 s44, s46, 7
    buffer_load_dwordx4 v6, s[8:11], s44 offen lds
    ds_read_b128 v[156:159], v11 offset:0
    ds_read_b64_tr_b16 v[248:249], v18 offset:4096
    ds_read_b64_tr_b16 v[250:251], v18 offset:5120
    ds_read_b64_tr_b16 v[252:253], v19 offset:4096
    ds_read_b64_tr_b16 v[254:255], v19 offset:5120
    s_waitcnt lgkmcnt(10)
    v_mfma_f32_32x32x16_bf16 v[56:71], v[40:43], v[148:151], v[56:71]
    v_mfma_f32_32x32x16_bf16 v[72:87], v[44:47], v[148:151], v[72:87]
    s_add_u32 m0, s47, 66560
    s_lshl_b32 s44, s46, 7
    buffer_load_dwordx4 v7, s[8:11], s44 offen lds
    ds_read_b128 v[160:163], v12 offset:0
    ds_read_b64_tr_b16 v[40:41], v18 offset:8192
    ds_read_b64_tr_b16 v[42:43], v18 offset:9216
    ds_read_b64_tr_b16 v[44:45], v19 offset:8192
    ds_read_b64_tr_b16 v[46:47], v19 offset:9216
    s_waitcnt lgkmcnt(10)
    v_mfma_f32_32x32x16_bf16 v[56:71], v[48:51], v[152:155], v[56:71]
    v_mfma_f32_32x32x16_bf16 v[72:87], v[52:55], v[152:155], v[72:87]
    s_add_u32 m0, s47, 81920
    s_mul_i32 s45, s46, 245760
    buffer_load_dwordx4 v8, s[12:15], s45 offen lds
    ds_read_b128 v[164:167], v13 offset:0
    ds_read_b64_tr_b16 v[48:49], v18 offset:12288
    ds_read_b64_tr_b16 v[50:51], v18 offset:13312
    ds_read_b64_tr_b16 v[52:53], v19 offset:12288
    ds_read_b64_tr_b16 v[54:55], v19 offset:13312
    s_waitcnt lgkmcnt(10)
    v_mfma_f32_32x32x16_bf16 v[56:71], v[248:251], v[156:159], v[56:71]
    v_mfma_f32_32x32x16_bf16 v[72:87], v[252:255], v[156:159], v[72:87]
    s_add_u32 m0, s47, 82944
    s_add_u32 s45, s45, 15360
    buffer_load_dwordx4 v8, s[12:15], s45 offen lds
    s_lshr_b64 s[98:99], s[98:99], 4
    s_and_b32 s46, s98, 15
    s_waitcnt vmcnt(4)
    s_barrier
    ds_read_b128 v[168:171], v10 offset:32768
    ds_read_b64_tr_b16 v[248:249], v18 offset:32768
    ds_read_b64_tr_b16 v[250:251], v18 offset:33792
    ds_read_b64_tr_b16 v[252:253], v19 offset:32768
    ds_read_b64_tr_b16 v[254:255], v19 offset:33792
    s_waitcnt lgkmcnt(10)
    v_mfma_f32_32x32x16_bf16 v[56:71], v[40:43], v[160:163], v[56:71]
    v_mfma_f32_32x32x16_bf16 v[72:87], v[44:47], v[160:163], v[72:87]
    s_add_u32 m0, s47, 98304
    s_lshl_b32 s44, s46, 7
    buffer_load_dwordx4 v6, s[8:11], s44 offen lds
    ds_read_b128 v[172:175], v11 offset:32768
    ds_read_b64_tr_b16 v[40:41], v18 offset:36864
    ds_read_b64_tr_b16 v[42:43], v18 offset:37888
    ds_read_b64_tr_b16 v[44:45], v19 offset:36864
    ds_read_b64_tr_b16 v[46:47], v19 offset:37888
    s_waitcnt lgkmcnt(10)
    v_mfma_f32_32x32x16_bf16 v[56:71], v[48:51], v[164:167], v[56:71]
    v_mfma_f32_32x32x16_bf16 v[72:87], v[52:55], v[164:167], v[72:87]
    s_add_u32 m0, s47, 99328
    s_lshl_b32 s44, s46, 7
    buffer_load_dwordx4 v7, s[8:11], s44 offen lds
    ds_read_b128 v[176:179], v12 offset:32768
    ds_read_b64_tr_b16 v[48:49], v18 offset:40960
    ds_read_b64_tr_b16 v[50:51], v18 offset:41984
    ds_read_b64_tr_b16 v[52:53], v19 offset:40960
    ds_read_b64_tr_b16 v[54:55], v19 offset:41984
    s_waitcnt lgkmcnt(10)
    v_mfma_f32_32x32x16_bf16 v[56:71], v[248:251], v[168:171], v[56:71]
    v_mfma_f32_32x32x16_bf16 v[72:87], v[252:255], v[168:171], v[72:87]
    s_add_u32 m0, s47, 114688
    s_mul_i32 s45, s46, 245760
    buffer_load_dwordx4 v8, s[12:15], s45 offen lds
    ds_read_b128 v[180:183], v13 offset:32768
    ds_read_b64_tr_b16 v[248:249], v18 offset:45056
    ds_read_b64_tr_b16 v[250:251], v18 offset:46080
    ds_read_b64_tr_b16 v[252:253], v19 offset:45056
    ds_read_b64_tr_b16 v[254:255], v19 offset:46080
    s_waitcnt lgkmcnt(10)
    v_mfma_f32_32x32x16_bf16 v[56:71], v[40:43], v[172:175], v[56:71]
    v_mfma_f32_32x32x16_bf16 v[72:87], v[44:47], v[172:175], v[72:87]
    s_add_u32 m0, s47, 115712
    s_add_u32 s45, s45, 15360
    buffer_load_dwordx4 v8, s[12:15], s45 offen lds
    s_lshr_b64 s[98:99], s[98:99], 4
    s_and_b32 s46, s98, 15
    s_waitcnt vmcnt(4)
    s_barrier
    ds_read_b128 v[184:187], v14 offset:0
    ds_read_b64_tr_b16 v[40:41], v20 offset:0
    ds_read_b64_tr_b16 v[42:43], v20 offset:1024
    ds_read_b64_tr_b16 v[44:45], v21 offset:0
    ds_read_b64_tr_b16 v[46:47], v21 offset:1024
    s_cmp_lg_u32 s38, 7
    s_cbranch_scc1 L_pw_14
    s_lshl_b32 s60, s40, 9
    s_add_u32 s60, s60, 10698752
    v_min_u32 v0, 19, v2
    v_lshlrev_b32 v0, 4, v0
    buffer_load_dword v34, v0, s[16:19], s60 offen sc0 sc1
L_pw_14:
    s_waitcnt lgkmcnt(10)
    v_mfma_f32_32x32x16_bf16 v[56:71], v[48:51], v[176:179], v[56:71]
    v_mfma_f32_32x32x16_bf16 v[72:87], v[52:55], v[176:179], v[72:87]
    s_add_u32 m0, s47, 0
    s_lshl_b32 s44, s46, 7
    buffer_load_dwordx4 v6, s[8:11], s44 offen lds
    ds_read_b128 v[188:191], v15 offset:0
    ds_read_b64_tr_b16 v[48:49], v20 offset:4096
    ds_read_b64_tr_b16 v[50:51], v20 offset:5120
    ds_read_b64_tr_b16 v[52:53], v21 offset:4096
    ds_read_b64_tr_b16 v[54:55], v21 offset:5120
    s_waitcnt lgkmcnt(10)
    v_mfma_f32_32x32x16_bf16 v[56:71], v[248:251], v[180:183], v[56:71]
    v_mfma_f32_32x32x16_bf16 v[72:87], v[252:255], v[180:183], v[72:87]
    s_add_u32 m0, s47, 1024
    s_lshl_b32 s44, s46, 7
    buffer_load_dwordx4 v7, s[8:11], s44 offen lds
    ds_read_b128 v[192:195], v16 offset:0
    ds_read_b64_tr_b16 v[248:249], v20 offset:8192
    ds_read_b64_tr_b16 v[250:251], v20 offset:9216
    ds_read_b64_tr_b16 v[252:253], v21 offset:8192
    ds_read_b64_tr_b16 v[254:255], v21 offset:9216
    s_waitcnt lgkmcnt(10)
    v_mfma_f32_32x32x16_bf16 v[56:71], v[40:43], v[184:187], v[56:71]
    v_mfma_f32_32x32x16_bf16 v[72:87], v[44:47], v[184:187], v[72:87]
    s_add_u32 m0, s47, 16384
    s_mul_i32 s45, s46, 245760
    buffer_load_dwordx4 v8, s[12:15], s45 offen lds
    ds_read_b128 v[196:199], v17 offset:0
    ds_read_b64_tr_b16 v[40:41], v20 offset:12288
    ds_read_b64_tr_b16 v[42:43], v20 offset:13312
    ds_read_b64_tr_b16 v[44:45], v21 offset:12288
    ds_read_b64_tr_b16 v[46:47], v21 offset:13312
    s_waitcnt lgkmcnt(10)
    v_mfma_f32_32x32x16_bf16 v[56:71], v[48:51], v[188:191], v[56:71]
    v_mfma_f32_32x32x16_bf16 v[72:87], v[52:55], v[188:191], v[72:87]
    s_add_u32 m0, s47, 17408
    s_add_u32 s45, s45, 15360
    buffer_load_dwordx4 v8, s[12:15], s45 offen lds
    s_lshr_b64 s[98:99], s[98:99], 4
    s_and_b32 s46, s98, 15
    s_waitcnt vmcnt(4)
    s_barrier
    ds_read_b128 v[200:203], v14 offset:32768
    ds_read_b64_tr_b16 v[48:49], v20 offset:32768
    ds_read_b64_tr_b16 v[50:51], v20 offset:33792
    ds_read_b64_tr_b16 v[52:53], v21 offset:32768
    ds_read_b64_tr_b16 v[54:55], v21 offset:33792
    s_waitcnt lgkmcnt(10)
    v_mfma_f32_32x32x16_bf16 v[56:71], v[248:251], v[192:195], v[56:71]
    v_mfma_f32_32x32x16_bf16 v[72:87], v[252:255], v[192:195], v[72:87]
    s_add_u32 m0, s47, 32768
    s_lshl_b32 s44, s46, 7
    buffer_load_dwordx4 v6, s[8:11], s44 offen lds
    ds_read_b128 v[204:207], v15 offset:32768
    ds_read_b64_tr_b16 v[248:249], v20 offset:36864
    ds_read_b64_tr_b16 v[250:251], v20 offset:37888
    ds_read_b64_tr_b16 v[252:253], v21 offset:36864
    ds_read_b64_tr_b16 v[254:255], v21 offset:37888
    s_waitcnt lgkmcnt(10)
    v_mfma_f32_32x32x16_bf16 v[56:71], v[40:43], v[196:199], v[56:71]
    v_mfma_f32_32x32x16_bf16 v[72:87], v[44:47], v[196:199], v[72:87]
    s_add_u32 m0, s47, 33792
    s_lshl_b32 s44, s46, 7
    buffer_load_dwordx4 v7, s[8:11], s44 offen lds
    ds_read_b128 v[208:211], v16 offset:32768
    ds_read_b64_tr_b16 v[40:41], v20 offset:40960
    ds_read_b64_tr_b16 v[42:43], v20 offset:41984
    ds_read_b64_tr_b16 v[44:45], v21 offset:40960
    ds_read_b64_tr_b16 v[46:47], v21 offset:41984
    s_waitcnt lgkmcnt(10)
    v_mfma_f32_32x32x16_bf16 v[56:71], v[48:51], v[200:203], v[56:71]
    v_mfma_f32_32x32x16_bf16 v[72:87], v[52:55], v[200:203], v[72:87]
    s_add_u32 m0, s47, 49152
    s_mul_i32 s45, s46, 245760
    buffer_load_dwordx4 v8, s[12:15], s45 offen lds
    ds_read_b128 v[212:215], v17 offset:32768
    ds_read_b64_tr_b16 v[48:49], v20 offset:45056
    ds_read_b64_tr_b16 v[50:51], v20 offset:46080
    ds_read_b64_tr_b16 v[52:53], v21 offset:45056
    ds_read_b64_tr_b16 v[54:55], v21 offset:46080
    s_waitcnt lgkmcnt(10)
    v_mfma_f32_32x32x16_bf16 v[56:71], v[248:251], v[204:207], v[56:71]
    v_mfma_f32_32x32x16_bf16 v[72:87], v[252:255], v[204:207], v[72:87]
    s_add_u32 m0, s47, 50176
    s_add_u32 s45, s45, 15360
    buffer_load_dwordx4 v8, s[12:15], s45 offen lds
    s_mov_b64 s[98:99], s[100:101]
    s_and_b32 s46, s98, 15
    s_waitcnt vmcnt(4)
    s_cmp_lg_u32 s38, 7
    s_cbranch_scc1 L_pw_15
    v_cmp_ne_u32 vcc, s43, v34
    s_cmp_eq_u32 s43, 0
    s_cselect_b32 s60, 1, 0
    s_nop 2
    s_and_b32 s61, vcc_lo, 0xfffff
    s_or_b32 s60, s60, s61
    s_cbranch_scc0 L_pw_15
    s_cmp_lg_u32 s43, 0
    s_cbranch_scc1 L_ngd_17
    v_mov_b32 v0, 0
    s_mov_b32 s62, 0x200000
L_ng_16:
    buffer_load_dword v1, v0, s[20:23], 0 offen sc0 sc1
    s_waitcnt vmcnt(0)
    v_readfirstlane_b32 s43, v1
    s_cmp_lg_u32 s43, 0
    s_cbranch_scc1 L_ngd_17
    s_sleep 8
    s_sub_u32 s62, s62, 1
    s_cmp_lg_u32 s62, 0
    s_cbranch_scc1 L_ng_16
L_ngd_17:
    s_lshl_b32 s60, s40, 9
    s_add_u32 s60, s60, 10698752
    v_min_u32 v0, 19, v2
    v_lshlrev_b32 v0, 4, v0
    s_mov_b32 s62, 0x200000
L_fw_18:
    buffer_load_dword v1, v0, s[16:19], s60 offen sc0 sc1
    s_waitcnt vmcnt(0)
    v_cmp_ne_u32 vcc, s43, v1
    s_nop 3
    s_cmp_eq_u64 vcc, 0
    s_cbranch_scc1 L_fwd_19
    s_sleep 10
    s_sub_u32 s62, s62, 1
    s_cmp_lg_u32 s62, 0
    s_cbranch_scc1 L_fw_18
L_fwd_19:
L_pw_15:
    s_barrier
    ds_read_b128 v[216:219], v10 offset:0
    ds_read_b64_tr_b16 v[248:249], v18 offset:0
    ds_read_b64_tr_b16 v[250:251], v18 offset:1024
    ds_read_b64_tr_b16 v[252:253], v19 offset:0
    ds_read_b64_tr_b16 v[254:255], v19 offset:1024
    s_waitcnt lgkmcnt(10)
    v_mfma_f32_32x32x16_bf16 v[56:71], v[40:43], v[208:211], v[56:71]
    v_mfma_f32_32x32x16_bf16 v[72:87], v[44:47], v[208:211], v[72:87]
    s_lshl_b32 s45, s46, 14
    s_add_u32 m0, s47, 131072
    s_add_u32 s45, s45, s50
    buffer_load_dwordx4 v3, s[16:19], s45 offen sc1 lds
    s_add_u32 m0, s47, 132096
    s_add_u32 s45, s45, 1024
    buffer_load_dwordx4 v3, s[16:19], s45 offen sc1 lds
    s_lshr_b64 s[98:99], s[98:99], 4
    s_and_b32 s46, s98, 15
    ds_read_b128 v[220:223], v11 offset:0
    ds_read_b64_tr_b16 v[40:41], v18 offset:4096
    ds_read_b64_tr_b16 v[42:43], v18 offset:5120
    ds_read_b64_tr_b16 v[44:45], v19 offset:4096
    ds_read_b64_tr_b16 v[46:47], v19 offset:5120
    s_waitcnt lgkmcnt(10)
    v_mfma_f32_32x32x16_bf16 v[56:71], v[48:51], v[212:215], v[56:71]
    v_mfma_f32_32x32x16_bf16 v[72:87], v[52:55], v[212:215], v[72:87]
    s_lshl_b32 s45, s46, 14
    s_add_u32 m0, s47, 147456
    s_add_u32 s45, s45, s50
    buffer_load_dwordx4 v3, s[16:19], s45 offen sc1 lds
    s_add_u32 m0, s47, 148480
    s_add_u32 s45, s45, 1024
    buffer_load_dwordx4 v3, s[16:19], s45 offen sc1 lds
    s_lshr_b64 s[98:99], s[98:99], 4
    s_and_b32 s46, s98, 15
    ds_read_b128 v[224:227], v12 offset:0
    ds_read_b64_tr_b16 v[48:49], v18 offset:8192
    ds_read_b64_tr_b16 v[50:51], v18 offset:9216
    ds_read_b64_tr_b16 v[52:53], v19 offset:8192
    ds_read_b64_tr_b16 v[54:55], v19 offset:9216
    s_waitcnt lgkmcnt(10)
    v_mfma_f32_32x32x16_bf16 v[56:71], v[248:251], v[216:219], v[56:71]
    v_mfma_f32_32x32x16_bf16 v[72:87], v[252:255], v[216:219], v[72:87]
    s_lshl_b32 s45, s46, 14
    s_add_u32 m0, s47, 65536
    s_add_u32 s45, s45, s50
    buffer_load_dwordx4 v3, s[16:19], s45 offen sc1 lds
    s_add_u32 m0, s47, 66560
    s_add_u32 s45, s45, 1024
    buffer_load_dwordx4 v3, s[16:19], s45 offen sc1 lds
    s_lshr_b64 s[98:99], s[98:99], 4
    s_and_b32 s46, s98, 15
    ds_read_b128 v[228:231], v13 offset:0
    ds_read_b64_tr_b16 v[248:249], v18 offset:12288
    ds_read_b64_tr_b16 v[250:251], v18 offset:13312
    ds_read_b64_tr_b16 v[252:253], v19 offset:12288
    ds_read_b64_tr_b16 v[254:255], v19 offset:13312
    s_waitcnt lgkmcnt(10)
    v_mfma_f32_32x32x16_bf16 v[56:71], v[40:43], v[220:223], v[56:71]
    v_mfma_f32_32x32x16_bf16 v[72:87], v[44:47], v[220:223], v[72:87]
    s_waitcnt vmcnt(6)
    s_barrier
    ds_read_b128 v[232:235], v10 offset:32768
    ds_read_b64_tr_b16 v[40:41], v18 offset:32768
    ds_read_b64_tr_b16 v[42:43], v18 offset:33792
    ds_read_b64_tr_b16 v[44:45], v19 offset:32768
    ds_read_b64_tr_b16 v[46:47], v19 offset:33792
    s_waitcnt lgkmcnt(10)
    v_mfma_f32_32x32x16_bf16 v[56:71], v[48:51], v[224:227], v[56:71]
    v_mfma_f32_32x32x16_bf16 v[72:87], v[52:55], v[224:227], v[72:87]
    s_lshl_b32 s45, s46, 14
    s_add_u32 m0, s47, 82432
    s_add_u32 s45, s45, s50
    buffer_load_dwordx4 v3, s[16:19], s45 offen sc1 lds
    ds_read_b128 v[236:239], v11 offset:32768
    ds_read_b64_tr_b16 v[48:49], v18 offset:36864
    ds_read_b64_tr_b16 v[50:51], v18 offset:37888
    ds_read_b64_tr_b16 v[52:53], v19 offset:36864
    ds_read_b64_tr_b16 v[54:55], v19 offset:37888
    s_waitcnt lgkmcnt(10)
    v_mfma_f32_32x32x16_bf16 v[56:71], v[248:251], v[228:231], v[56:71]
    v_mfma_f32_32x32x16_bf16 v[72:87], v[252:255], v[228:231], v[72:87]
    s_add_u32 m0, s47, 83456
    s_add_u32 s45, s45, 1024
    buffer_load_dwordx4 v3, s[16:19], s45 offen sc1 lds
    s_lshr_b64 s[98:99], s[98:99], 4
    s_and_b32 s46, s98, 15
    ds_read_b128 v[240:243], v12 offset:32768
    ds_read_b64_tr_b16 v[248:249], v18 offset:40960
    ds_read_b64_tr_b16 v[250:251], v18 offset:41984
    ds_read_b64_tr_b16 v[252:253], v19 offset:40960
    ds_read_b64_tr_b16 v[254:255], v19 offset:41984
    s_waitcnt lgkmcnt(10)
    v_mfma_f32_32x32x16_bf16 v[56:71], v[40:43], v[232:235], v[56:71]
    v_mfma_f32_32x32x16_bf16 v[72:87], v[44:47], v[232:235], v[72:87]
    s_lshl_b32 s45, s46, 14
    s_add_u32 m0, s47, 98816
    s_add_u32 s45, s45, s50
    buffer_load_dwordx4 v3, s[16:19], s45 offen sc1 lds
    ds_read_b128 v[244:247], v13 offset:32768
    ds_read_b64_tr_b16 v[40:41], v18 offset:45056
    ds_read_b64_tr_b16 v[42:43], v18 offset:46080
    ds_read_b64_tr_b16 v[44:45], v19 offset:45056
    ds_read_b64_tr_b16 v[46:47], v19 offset:46080
    s_waitcnt lgkmcnt(10)
    v_mfma_f32_32x32x16_bf16 v[56:71], v[48:51], v[236:239], v[56:71]
    v_mfma_f32_32x32x16_bf16 v[72:87], v[52:55], v[236:239], v[72:87]
    s_add_u32 m0, s47, 99840
    s_add_u32 s45, s45, 1024
    buffer_load_dwordx4 v3, s[16:19], s45 offen sc1 lds
    s_lshr_b64 s[98:99], s[98:99], 4
    s_and_b32 s46, s98, 15
    s_waitcnt vmcnt(6)
    s_barrier
    ds_read_b128 v[48:51], v23 offset:0
    ds_read_b128 v[52:55], v23 offset:1024
    s_waitcnt lgkmcnt(7)
    v_mfma_f32_32x32x16_bf16 v[56:71], v[248:251], v[240:243], v[56:71]
    v_mfma_f32_32x32x16_bf16 v[72:87], v[252:255], v[240:243], v[72:87]
    s_lshl_b32 s45, s46, 14
    s_add_u32 m0, s47, 0
    s_add_u32 s45, s45, s50
    buffer_load_dwordx4 v3, s[16:19], s45 offen sc1 lds
    ds_read_b128 v[248:251], v23 offset:4096
    ds_read_b128 v[252:255], v23 offset:5120
    s_waitcnt lgkmcnt(4)
    v_mfma_f32_32x32x16_bf16 v[56:71], v[40:43], v[244:247], v[56:71]
    v_mfma_f32_32x32x16_bf16 v[72:87], v[44:47], v[244:247], v[72:87]
    s_add_u32 m0, s47, 1024
    s_add_u32 s45, s45, 1024
    buffer_load_dwordx4 v3, s[16:19], s45 offen sc1 lds
    s_lshr_b64 s[98:99], s[98:99], 4
    s_and_b32 s46, s98, 15
    s_mov_b32 s65, s64
    s_cmp_ge_u32 s40, 5
    s_nop 7
    s_nop 1
    s_cbranch_scc1 L_p1_cv
    v_pk_mul_f32 v[56:57], v[56:57], s[64:65]
    v_pk_mul_f32 v[58:59], v[58:59], s[64:65]
    v_pk_mul_f32 v[60:61], v[60:61], s[64:65]
    v_pk_mul_f32 v[62:63], v[62:63], s[64:65]
    v_cvt_pk_bf16_f32 v8, v56, v57
    v_cvt_pk_bf16_f32 v9, v58, v59
    v_cvt_pk_bf16_f32 v10, v60, v61
    v_cvt_pk_bf16_f32 v11, v62, v63
    v_pk_mul_f32 v[64:65], v[64:65], s[64:65]
    v_pk_mul_f32 v[66:67], v[66:67], s[64:65]
    v_pk_mul_f32 v[68:69], v[68:69], s[64:65]
    v_pk_mul_f32 v[70:71], v[70:71], s[64:65]
    v_cvt_pk_bf16_f32 v12, v64, v65
    v_cvt_pk_bf16_f32 v13, v66, v67
    v_cvt_pk_bf16_f32 v14, v68, v69
    v_cvt_pk_bf16_f32 v15, v70, v71
    v_pk_mul_f32 v[72:73], v[72:73], s[64:65]
    v_pk_mul_f32 v[74:75], v[74:75], s[64:65]
    v_pk_mul_f32 v[76:77], v[76:77], s[64:65]
    v_pk_mul_f32 v[78:79], v[78:79], s[64:65]
    v_cvt_pk_bf16_f32 v16, v72, v73
    v_cvt_pk_bf16_f32 v17, v74, v75
    v_cvt_pk_bf16_f32 v18, v76, v77
    v_cvt_pk_bf16_f32 v19, v78, v79
    v_pk_mul_f32 v[80:81], v[80:81], s[64:65]
    v_pk_mul_f32 v[82:83], v[82:83], s[64:65]
    v_pk_mul_f32 v[84:85], v[84:85], s[64:65]
    v_pk_mul_f32 v[86:87], v[86:87], s[64:65]
    v_cvt_pk_bf16_f32 v32, v80, v81
    v_cvt_pk_bf16_f32 v33, v82, v83
    v_cvt_pk_bf16_f32 v34, v84, v85
    v_cvt_pk_bf16_f32 v35, v86, v87
    s_branch L_p2
L_p1_x:
    s_mov_b64 s[4:5], 0
    s_mov_b64 s[6:7], 0
    s_mov_b64 s[74:75], 0
    s_mov_b64 s[76:77], 0
    v_add_u32 v56, 0x20000, v10
    v_mov_b32 v24, 2147483632
    v_add_u32 v57, 0x20000, v11
    v_mov_b32 v25, 2147483632
    v_add_u32 v58, 0x20000, v12
    v_mov_b32 v26, 2147483632
    v_add_u32 v59, 0x20000, v13
    v_mov_b32 v27, 2147483632
    s_mov_b32 s46, 0
    s_mov_b32 s98, 0x76543210
    s_mov_b32 s99, 0x98
    s_cmp_eq_u32 s49, 0
    s_cbranch_scc1 L_x_ld
    v_bfe_u32 v36, v2, 2, 2
    v_lshl_add_u32 v36, v5, 3, v36
    v_and_b32 v37, 1, v2
    v_mul_u32_u24 v37, 20, v37
    v_sub_u32 v38, v36, v37
    v_bfe_u32 v39, v2, 1, 1
    v_bfe_u32 v1, v2, 4, 1
    v_lshl_add_u32 v39, v1, 1, v39
    v_mul_u32_u24 v36, 40, v36
    v_add_u32 v36, s55, v36
    v_lshl_add_u32 v0, v39, 3, v36
    v_cmp_eq_u32 s[58:59], 0, v39
    s_add_u32 s57, s55, 1600
    v_mov_b32 v37, s57
    s_waitcnt vmcnt(10)
    v_add_u32 v1, 0, v38
    v_cmp_gt_u32 vcc, 20, v1
    v_add_u32 v1, 0, v0
    v_add_u32 v39, 32, v36
    v_cndmask_b32 v1, v37, v1, vcc
    s_and_b64 vcc, vcc, s[58:59]
    ds_read_b64_tr_b16 v[168:169], v1
    v_cndmask_b32 v39, v37, v39, vcc
    ds_read_b64_tr_b16 v[180:181], v39
    v_add_u32 v1, 4, v38
    v_cmp_gt_u32 vcc, 20, v1
    v_add_u32 v1, 160, v0
    v_add_u32 v39, 192, v36
    v_cndmask_b32 v1, v37, v1, vcc
    s_and_b64 vcc, vcc, s[58:59]
    ds_read_b64_tr_b16 v[170:171], v1
    v_cndmask_b32 v39, v37, v39, vcc
    ds_read_b64_tr_b16 v[182:183], v39
    v_add_u32 v1, 16, v38
    v_cmp_gt_u32 vcc, 20, v1
    v_add_u32 v1, 640, v0
    v_add_u32 v39, 672, v36
    v_cndmask_b32 v1, v37, v1, vcc
    s_and_b64 vcc, vcc, s[58:59]
    ds_read_b64_tr_b16 v[172:173], v1
    v_cndmask_b32 v39, v37, v39, vcc
    ds_read_b64_tr_b16 v[184:185], v39
    v_add_u32 v1, 20, v38
    v_cmp_gt_u32 vcc, 20, v1
    v_add_u32 v1, 800, v0
    v_add_u32 v39, 832, v36
    v_cndmask_b32 v1, v37, v1, vcc
    s_and_b64 vcc, vcc, s[58:59]
    ds_read_b64_tr_b16 v[174:175], v1
    v_cndmask_b32 v39, v37, v39, vcc
    ds_read_b64_tr_b16 v[186:187], v39
    v_add_u32 v1, 32, v38
    v_cmp_gt_u32 vcc, 20, v1
    v_add_u32 v1, 1280, v0
    v_add_u32 v39, 1312, v36
    v_cndmask_b32 v1, v37, v1, vcc
    s_and_b64 vcc, vcc, s[58:59]
    ds_read_b64_tr_b16 v[176:177], v1
    v_cndmask_b32 v39, v37, v39, vcc
    ds_read_b64_tr_b16 v[188:189], v39
    v_add_u32 v1, 36, v38
    v_cmp_gt_u32 vcc, 20, v1
    v_add_u32 v1, 1440, v0
    v_add_u32 v39, 1472, v36
    v_cndmask_b32 v1, v37, v1, vcc
    s_and_b64 vcc, vcc, s[58:59]
    ds_read_b64_tr_b16 v[178:179], v1
    v_cndmask_b32 v39, v37, v39, vcc
    ds_read_b64_tr_b16 v[190:191], v39
    v_and_b32 v0, 3, v4
    v_lshlrev_b32 v0, 4, v0
    v_mov_b32 v36, 0x3f80
    v_mov_b32 v37, 0
    v_lshlrev_b64 v[36:37], v0, v[36:37]
    v_bfe_u32 v0, v4, 2, 1
    v_mul_u32_u24 v0, 5, v0
    v_lshrrev_b32 v1, 3, v4
    v_add_u32 v0, v0, v1
    v_lshlrev_b32 v38, 1, v5
    v_sub_u32 v0, v0, v38
    v_cmp_eq_u32 vcc, 0, v1
    v_mov_b32 v38, 99
    s_nop 0
    v_cndmask_b32 v0, v0, v38, vcc
    v_cmp_eq_u32 s[58:59], 3, v1
    v_cmp_eq_u32 vcc, 1, v0
    s_nop 1
    v_cndmask_b32 v192, 0, v36, vcc
    v_cndmask_b32 v193, 0, v37, vcc
    v_cmp_eq_u32 vcc, -2, v0
    s_nop 1
    v_cndmask_b32 v204, 0, v36, vcc
    v_cndmask_b32 v205, 0, v37, vcc
    v_cmp_eq_u32 vcc, 2, v0
    s_nop 1
    v_cndmask_b32 v194, 0, v36, vcc
    v_cndmask_b32 v195, 0, v37, vcc
    v_cmp_eq_u32 vcc, -1, v0
    s_nop 1
    v_cndmask_b32 v206, 0, v36, vcc
    v_cndmask_b32 v207, 0, v37, vcc
    v_cmp_eq_u32 vcc, 5, v0
    s_nop 1
    v_cndmask_b32 v196, 0, v36, vcc
    v_cndmask_b32 v197, 0, v37, vcc
    v_cmp_eq_u32 vcc, 2, v0
    s_nop 1
    v_cndmask_b32 v208, 0, v36, vcc
    v_cndmask_b32 v209, 0, v37, vcc
    v_cmp_eq_u32 vcc, 6, v0
    s_nop 1
    v_cndmask_b32 v198, 0, v36, vcc
    v_cndmask_b32 v199, 0, v37, vcc
    v_cmp_eq_u32 vcc, 3, v0
    s_nop 1
    v_cndmask_b32 v210, 0, v36, vcc
    v_cndmask_b32 v211, 0, v37, vcc
    v_cmp_eq_u32 vcc, 9, v0
    s_nop 1
    v_cndmask_b32 v200, 0, v36, vcc
    v_cndmask_b32 v201, 0, v37, vcc
    v_cmp_eq_u32 vcc, 6, v0
    s_nop 1
    v_cndmask_b32 v212, 0, v36, vcc
    v_cndmask_b32 v213, 0, v37, vcc
    v_cmp_eq_u32 vcc, 10, v0
    s_nop 1
    v_cndmask_b32 v202, 0, v36, vcc
    v_cndmask_b32 v203, 0, v37, vcc
    v_cmp_eq_u32 vcc, 7, v0
    s_nop 1
    v_cndmask_b32 v214, 0, v36, vcc
    v_cndmask_b32 v215, 0, v37, vcc
    s_mul_i32 s54, s52, 163840
    s_lshl_b32 s56, s53, 13
    s_add_u32 s54, s54, s56
    s_add_u32 s54, s54, 7929856
    s_add_u32 s56, s54, 4096
    v_and_b32 v36, 0x13, v4
    v_bfe_u32 v38, v4, 2, 1
    v_lshl_or_b32 v36, v38, 3, v36
    v_bfe_u32 v38, v4, 3, 1
    v_lshl_or_b32 v36, v38, 2, v36
    v_lshrrev_b32 v37, 2, v36
    v_mul_u32_u24 v37, 1040, v37
    v_and_b32 v36, 3, v36
    v_lshl_add_u32 v36, v36, 8, v37
    v_lshl_add_u32 v36, v5, 4, v36
    v_add_u32 v36, s55, v36
    s_waitcnt vmcnt(0)
    ds_read_b128 v[124:127], v36 offset:2048
    ds_read_b128 v[128:131], v36 offset:2080
    ds_read_b128 v[132:135], v36 offset:2112
    ds_read_b128 v[136:139], v36 offset:2128
    ds_read_b128 v[140:143], v36 offset:2160
    ds_read_b128 v[144:147], v36 offset:2192
    ds_read_b128 v[148:151], v36 offset:2208
    ds_read_b128 v[152:155], v36 offset:2240
    ds_read_b128 v[156:159], v36 offset:2272
    s_waitcnt lgkmcnt(0)
    v_mfma_f32_32x32x16_bf16 v[216:231], v[124:127], v[168:171], 0
    v_mfma_f32_32x32x16_bf16 v[216:231], v[128:131], v[172:175], v[216:231]
    v_mfma_f32_32x32x16_bf16 v[216:231], v[132:135], v[176:179], v[216:231]
    v_mfma_f32_32x32x16_bf16 v[232:247], v[124:127], v[180:183], 0
    v_mfma_f32_32x32x16_bf16 v[232:247], v[128:131], v[184:187], v[232:247]
    v_mfma_f32_32x32x16_bf16 v[232:247], v[132:135], v[188:191], v[232:247]
    v_mfma_f32_32x32x16_bf16 v[232:247], v[148:151], v[192:195], v[232:247]
    v_mfma_f32_32x32x16_bf16 v[232:247], v[152:155], v[196:199], v[232:247]
    v_mfma_f32_32x32x16_bf16 v[232:247], v[156:159], v[200:203], v[232:247]
    v_mov_b32 v0, 0
    buffer_load_dword v35, v0, s[20:23], 0 offen sc0 sc1
    s_nop 6
    v_cvt_pk_bf16_f32 v216, v216, v217
    v_cvt_pk_bf16_f32 v217, v218, v219
    v_cvt_pk_bf16_f32 v218, v220, v221
    v_cvt_pk_bf16_f32 v219, v222, v223
    v_cvt_pk_bf16_f32 v224, v224, v225
    v_cvt_pk_bf16_f32 v225, v226, v227
    v_cvt_pk_bf16_f32 v226, v228, v229
    v_cvt_pk_bf16_f32 v227, v230, v231
    buffer_store_dwordx4 v[216:219], v3, s[16:19], s54 offen offset:0 sc1
    buffer_store_dwordx4 v[224:227], v3, s[16:19], s56 offen offset:0 sc1
    s_nop 1
    v_mfma_f32_32x32x16_bf16 v[216:231], v[136:139], v[168:171], 0
    v_mfma_f32_32x32x16_bf16 v[216:231], v[140:143], v[172:175], v[216:231]
    v_mfma_f32_32x32x16_bf16 v[216:231], v[144:147], v[176:179], v[216:231]
    v_cvt_pk_bf16_f32 v232, v232, v233
    v_cvt_pk_bf16_f32 v233, v234, v235
    v_cvt_pk_bf16_f32 v234, v236, v237
    v_cvt_pk_bf16_f32 v235, v238, v239
    v_cvt_pk_bf16_f32 v240, v240, v241
    v_cvt_pk_bf16_f32 v241, v242, v243
    v_cvt_pk_bf16_f32 v242, v244, v245
    v_cvt_pk_bf16_f32 v243, v246, v247
    buffer_store_dwordx4 v[232:235], v3, s[16:19], s54 offen offset:1024 sc1
    buffer_store_dwordx4 v[240:243], v3, s[16:19], s56 offen offset:1024 sc1
    s_nop 1
    v_mfma_f32_32x32x16_bf16 v[232:247], v[136:139], v[180:183], 0
    v_mfma_f32_32x32x16_bf16 v[232:247], v[140:143], v[184:187], v[232:247]
    v_mfma_f32_32x32x16_bf16 v[232:247], v[144:147], v[188:191], v[232:247]
    v_mfma_f32_32x32x16_bf16 v[232:247], v[148:151], v[204:207], v[232:247]
    v_mfma_f32_32x32x16_bf16 v[232:247], v[152:155], v[208:211], v[232:247]
    v_mfma_f32_32x32x16_bf16 v[232:247], v[156:159], v[212:215], v[232:247]
    v_cvt_pk_bf16_f32 v216, v216, v217
    v_cvt_pk_bf16_f32 v217, v218, v219
    v_cvt_pk_bf16_f32 v218, v220, v221
    v_cvt_pk_bf16_f32 v219, v222, v223
    v_cvt_pk_bf16_f32 v224, v224, v225
    v_cvt_pk_bf16_f32 v225, v226, v227
    v_cvt_pk_bf16_f32 v226, v228, v229
    v_cvt_pk_bf16_f32 v227, v230, v231
    buffer_store_dwordx4 v[216:219], v3, s[16:19], s54 offen offset:2048 sc1
    buffer_store_dwordx4 v[224:227], v3, s[16:19], s56 offen offset:2048 sc1
    s_nop 3
    v_cvt_pk_bf16_f32 v232, v232, v233
    v_cvt_pk_bf16_f32 v233, v234, v235
    v_cvt_pk_bf16_f32 v234, v236, v237
    v_cvt_pk_bf16_f32 v235, v238, v239
    v_cndmask_b32 v232, v232, v160, s[58:59]
    v_cndmask_b32 v233, v233, v161, s[58:59]
    v_cndmask_b32 v234, v234, v162, s[58:59]
    v_cndmask_b32 v235, v235, v163, s[58:59]
    v_cvt_pk_bf16_f32 v240, v240, v241
    v_cvt_pk_bf16_f32 v241, v242, v243
    v_cvt_pk_bf16_f32 v242, v244, v245
    v_cvt_pk_bf16_f32 v243, v246, v247
    v_cndmask_b32 v240, v240, v164, s[58:59]
    v_cndmask_b32 v241, v241, v165, s[58:59]
    v_cndmask_b32 v242, v242, v166, s[58:59]
    v_cndmask_b32 v243, v243, v167, s[58:59]
    buffer_store_dwordx4 v[232:235], v3, s[16:19], s54 offen offset:3072 sc1
    buffer_store_dwordx4 v[240:243], v3, s[16:19], s56 offen offset:3072 sc1
    s_cmp_lg_u32 s53, 0
    s_cbranch_scc1 L_nz_20
    s_lshl_b32 s54, s52, 13
    s_add_u32 s54, s54, 10551296
    s_add_u32 s56, s54, 4096
    v_mov_b32 v124, 0
    v_mov_b32 v125, 0
    v_mov_b32 v126, 0
    v_mov_b32 v127, 0
    buffer_store_dwordx4 v[124:127], v3, s[16:19], s54 offen offset:0 sc1
    buffer_store_dwordx4 v[124:127], v3, s[16:19], s56 offen offset:0 sc1
    buffer_store_dwordx4 v[124:127], v3, s[16:19], s54 offen offset:1024 sc1
    buffer_store_dwordx4 v[124:127], v3, s[16:19], s56 offen offset:1024 sc1
    buffer_store_dwordx4 v[124:127], v3, s[16:19], s54 offen offset:2048 sc1
    buffer_store_dwordx4 v[124:127], v3, s[16:19], s56 offen offset:2048 sc1
    buffer_store_dwordx4 v[124:127], v3, s[16:19], s54 offen offset:3072 sc1
    buffer_store_dwordx4 v[124:127], v3, s[16:19], s56 offen offset:3072 sc1
L_nz_20:
    s_waitcnt vmcnt(0)
    v_readfirstlane_b32 s43, v35
    s_cmp_lg_u32 s43, 0
    s_cbranch_scc1 L_ngd_22
    v_mov_b32 v0, 0
    s_mov_b32 s62, 0x200000
L_ng_21:
    buffer_load_dword v1, v0, s[20:23], 0 offen sc0 sc1
    s_waitcnt vmcnt(0)
    v_readfirstlane_b32 s43, v1
    s_cmp_lg_u32 s43, 0
    s_cbranch_scc1 L_ngd_22
    s_sleep 8
    s_sub_u32 s62, s62, 1
    s_cmp_lg_u32 s62, 0
    s_cbranch_scc1 L_ng_21
L_ngd_22:
    s_lshl_b32 s60, s52, 5
    s_add_u32 s60, s60, s53
    s_lshl_b32 s60, s60, 4
    s_add_u32 s60, s60, 10698752
    v_mov_b32 v0, 0
    v_mov_b32 v1, s43
    s_mov_b64 exec, 1
    buffer_store_dword v1, v0, s[16:19], s60 offen sc0 sc1
    s_mov_b64 exec, -1
    s_barrier
    ds_read_b128 v[88:91], v56 offset:0
    ds_read_b128 v[92:95], v57 offset:0
    ds_read_b128 v[96:99], v58 offset:0
    ds_read_b128 v[100:103], v59 offset:0
    ds_read_b128 v[104:107], v56 offset:16384
    ds_read_b128 v[108:111], v57 offset:16384
    ds_read_b128 v[112:115], v58 offset:16384
    ds_read_b128 v[116:119], v59 offset:16384
    ds_read_b128 v[120:123], v14 offset:0
    ds_read_b128 v[124:127], v15 offset:0
    ds_read_b128 v[128:131], v16 offset:0
    ds_read_b128 v[132:135], v17 offset:0
    ds_read_b128 v[136:139], v14 offset:16384
    ds_read_b128 v[140:143], v15 offset:16384
    ds_read_b128 v[144:147], v16 offset:16384
    ds_read_b128 v[148:151], v17 offset:16384
    s_cmp_lg_u32 s38, 4
    s_cbranch_scc1 L_x_sync
    s_cmp_lg_u32 s43, 0
    s_cbranch_scc1 L_ngd_24
    v_mov_b32 v0, 0
    s_mov_b32 s62, 0x200000
L_ng_23:
    buffer_load_dword v1, v0, s[20:23], 0 offen sc0 sc1
    s_waitcnt vmcnt(0)
    v_readfirstlane_b32 s43, v1
    s_cmp_lg_u32 s43, 0
    s_cbranch_scc1 L_ngd_24
    s_sleep 8
    s_sub_u32 s62, s62, 1
    s_cmp_lg_u32 s62, 0
    s_cbranch_scc1 L_ng_23
L_ngd_24:
    s_lshl_b32 s60, s40, 9
    s_add_u32 s60, s60, 10698752
    v_min_u32 v0, 19, v2
    v_lshlrev_b32 v0, 4, v0
    s_mov_b32 s62, 0x200000
L_fw_25:
    buffer_load_dword v1, v0, s[16:19], s60 offen sc0 sc1
    s_waitcnt vmcnt(0)
    v_cmp_ne_u32 vcc, s43, v1
    s_nop 3
    s_cmp_eq_u64 vcc, 0
    s_cbranch_scc1 L_fwd_26
    s_sleep 10
    s_sub_u32 s62, s62, 1
    s_cmp_lg_u32 s62, 0
    s_cbranch_scc1 L_fw_25
L_fwd_26:
    s_branch L_x_sync
L_x_ld:
    s_sub_u32 s54, s38, 5
    s_mul_i32 s54, s54, 3
    s_sub_u32 s55, s54, s38
    s_mul_i32 s55, s55, 20480
    v_add_u32 v36, s55, v6
    v_add_u32 v37, s55, v7
    s_lshl_b32 s60, s54, 11
    s_mov_b32 s58, 0x10765498
    s_mov_b32 s59, 0x32
    s_mov_b32 s55, 0
    s_movk_i32 s57, 512
L_x_loop:
    s_and_b32 s54, s58, 15
    s_lshl_b32 s54, s54, 14
    s_add_u32 s54, s54, s60
    s_add_u32 m0, s54, 0
    s_add_u32 s56, s55, 0
    buffer_load_dwordx4 v36, s[8:11], s56 offen lds
    s_add_u32 m0, s54, 1024
    s_nop 0
    buffer_load_dwordx4 v37, s[8:11], s56 offen lds
    s_add_u32 m0, s54, 2048
    s_add_u32 s56, s55, 20480
    buffer_load_dwordx4 v36, s[8:11], s56 offen lds
    s_add_u32 m0, s54, 3072
    s_nop 0
    buffer_load_dwordx4 v37, s[8:11], s56 offen lds
    s_cmp_eq_u32 s38, 7
    s_cbranch_scc1 L_x_next
    s_add_u32 m0, s54, 4096
    s_add_u32 s56, s55, 40960
    buffer_load_dwordx4 v36, s[8:11], s56 offen lds
    s_add_u32 m0, s54, 5120
    s_nop 0
    buffer_load_dwordx4 v37, s[8:11], s56 offen lds
L_x_next:
    s_lshr_b64 s[58:59], s[58:59], 4
    s_add_u32 s55, s55, 128
    s_cmp_lt_u32 s55, s57
    s_cbranch_scc1 L_x_loop
    s_cmpk_eq_u32 s57, 1280
    s_cbranch_scc1 L_x_rd
    s_movk_i32 s57, 1280
    s_waitcnt vmcnt(0)
    s_barrier
    s_branch L_x_loop
L_x_rd:
    ds_read_b128 v[88:91], v56 offset:0
    ds_read_b128 v[92:95], v57 offset:0
    ds_read_b128 v[96:99], v58 offset:0
    ds_read_b128 v[100:103], v59 offset:0
    ds_read_b128 v[104:107], v56 offset:16384
    ds_read_b128 v[108:111], v57 offset:16384
    ds_read_b128 v[112:115], v58 offset:16384
    ds_read_b128 v[116:119], v59 offset:16384
    ds_read_b128 v[120:123], v14 offset:0
    ds_read_b128 v[124:127], v15 offset:0
    ds_read_b128 v[128:131], v16 offset:0
    ds_read_b128 v[132:135], v17 offset:0
    ds_read_b128 v[136:139], v14 offset:16384
    ds_read_b128 v[140:143], v15 offset:16384
    ds_read_b128 v[144:147], v16 offset:16384
    ds_read_b128 v[148:151], v17 offset:16384
L_x_sync:
    s_waitcnt lgkmcnt(0)
    s_barrier
    s_lshl_b32 s45, s46, 14
    s_add_u32 m0, s47, 131072
    s_add_u32 s45, s45, s50
    buffer_load_dwordx4 v3, s[16:19], s45 offen sc1 lds
    s_add_u32 m0, s47, 132096
    s_add_u32 s45, s45, 1024
    buffer_load_dwordx4 v3, s[16:19], s45 offen sc1 lds
    s_lshr_b64 s[98:99], s[98:99], 4
    s_and_b32 s46, s98, 15
    s_lshl_b32 s45, s46, 14
    s_add_u32 m0, s47, 147456
    s_add_u32 s45, s45, s50
    buffer_load_dwordx4 v3, s[16:19], s45 offen sc1 lds
    s_add_u32 m0, s47, 148480
    s_add_u32 s45, s45, 1024
    buffer_load_dwordx4 v3, s[16:19], s45 offen sc1 lds
    s_lshr_b64 s[98:99], s[98:99], 4
    s_and_b32 s46, s98, 15
    s_lshl_b32 s45, s46, 14
    s_add_u32 m0, s47, 65536
    s_add_u32 s45, s45, s50
    buffer_load_dwordx4 v3, s[16:19], s45 offen sc1 lds
    s_add_u32 m0, s47, 66560
    s_add_u32 s45, s45, 1024
    buffer_load_dwordx4 v3, s[16:19], s45 offen sc1 lds
    s_lshr_b64 s[98:99], s[98:99], 4
    s_and_b32 s46, s98, 15
    s_waitcnt vmcnt(6)
    s_barrier
    ds_read_b128 v[152:155], v14 offset:32768
    ds_read_b128 v[156:159], v15 offset:32768
    ds_read_b128 v[160:163], v16 offset:32768
    ds_read_b128 v[164:167], v17 offset:32768
    ds_read_b128 v[168:171], v14 offset:49152
    ds_read_b128 v[172:175], v15 offset:49152
    ds_read_b128 v[176:179], v16 offset:49152
    ds_read_b128 v[180:183], v17 offset:49152
    ds_read_b128 v[184:187], v10 offset:0
    ds_read_b128 v[188:191], v11 offset:0
    ds_read_b128 v[192:195], v12 offset:0
    ds_read_b128 v[196:199], v13 offset:0
    ds_read_b128 v[200:203], v10 offset:16384
    ds_read_b128 v[204:207], v11 offset:16384
    ds_read_b128 v[208:211], v12 offset:16384
    ds_read_b128 v[212:215], v13 offset:16384
    ds_read_b128 v[216:219], v10 offset:32768
    ds_read_b128 v[220:223], v11 offset:32768
    ds_read_b128 v[224:227], v12 offset:32768
    ds_read_b128 v[228:231], v13 offset:32768
    ds_read_b128 v[232:235], v10 offset:49152
    ds_read_b128 v[236:239], v11 offset:49152
    ds_read_b128 v[240:243], v12 offset:49152
    ds_read_b128 v[244:247], v13 offset:49152
    s_waitcnt lgkmcnt(0)
    s_barrier
    s_lshl_b32 s45, s46, 14
    s_add_u32 m0, s47, 82432
    s_add_u32 s45, s45, s50
    buffer_load_dwordx4 v3, s[16:19], s45 offen sc1 lds
    s_add_u32 m0, s47, 83456
    s_add_u32 s45, s45, 1024
    buffer_load_dwordx4 v3, s[16:19], s45 offen sc1 lds
    s_lshr_b64 s[98:99], s[98:99], 4
    s_and_b32 s46, s98, 15
    s_lshl_b32 s45, s46, 14
    s_add_u32 m0, s47, 98816
    s_add_u32 s45, s45, s50
    buffer_load_dwordx4 v3, s[16:19], s45 offen sc1 lds
    s_add_u32 m0, s47, 99840
    s_add_u32 s45, s45, 1024
    buffer_load_dwordx4 v3, s[16:19], s45 offen sc1 lds
    s_lshr_b64 s[98:99], s[98:99], 4
    s_and_b32 s46, s98, 15
    s_lshl_b32 s45, s46, 14
    s_add_u32 m0, s47, 0
    s_add_u32 s45, s45, s50
    buffer_load_dwordx4 v3, s[16:19], s45 offen sc1 lds
    s_add_u32 m0, s47, 1024
    s_add_u32 s45, s45, 1024
    buffer_load_dwordx4 v3, s[16:19], s45 offen sc1 lds
    s_lshr_b64 s[98:99], s[98:99], 4
    s_and_b32 s46, s98, 15
    s_waitcnt vmcnt(6)
    s_barrier
    ds_read_b128 v[48:51], v23 offset:0
    ds_read_b128 v[52:55], v23 offset:1024
    ds_read_b128 v[248:251], v23 offset:4096
    ds_read_b128 v[252:255], v23 offset:5120
    s_branch L_p2
L_p1_v:
    s_mov_b64 s[4:5], 0
    s_mov_b64 s[6:7], 0
    s_mov_b64 s[74:75], 0
    s_mov_b64 s[76:77], 0
    s_sub_u32 s54, s40, 10
    s_lshl_b32 s54, s54, 7
    s_lshl_b32 s56, s42, 6
    s_add_u32 s54, s54, s56
    s_mul_i32 s63, s48, 2560
    s_add_u32 s63, s63, 2622720
    s_mov_b32 s58, 163840
    v_mul_u32_u24 v36, 320, v5
    v_add_u32 v36, s63, v36
    v_add_u32 v38, s54, v4
    v_add_u32 v0, 0, v38
    v_mul_u32_u24 v1, 3277, v0
    v_lshrrev_b32 v1, 16, v1
    v_mul_u32_u24 v37, 20, v1
    v_sub_u32 v0, v0, v37
    v_mul_lo_u32 v1, v1, s58
    v_lshl_add_u32 v1, v0, 4, v1
    v_add_u32 v24, v1, v36
    v_add_u32 v25, 640, v24
    v_add_u32 v0, 32, v38
    v_mul_u32_u24 v1, 3277, v0
    v_lshrrev_b32 v1, 16, v1
    v_mul_u32_u24 v37, 20, v1
    v_sub_u32 v0, v0, v37
    v_mul_lo_u32 v1, v1, s58
    v_lshl_add_u32 v1, v0, 4, v1
    v_add_u32 v26, v1, v36
    v_add_u32 v27, 640, v26
    s_cmp_lg_u32 s49, 0
    s_cbranch_scc1 L_pc_27
    s_waitcnt vmcnt(2)
    s_add_u32 m0, s47, 32768
    s_lshl_b32 s44, s46, 7
    buffer_load_dwordx4 v6, s[8:11], s44 offen lds
    s_add_u32 m0, s47, 33792
    s_lshl_b32 s44, s46, 7
    buffer_load_dwordx4 v7, s[8:11], s44 offen lds
    s_waitcnt vmcnt(2)
    s_add_u32 m0, s47, 49152
    s_mul_i32 s45, s46, 245760
    buffer_load_dwordx4 v8, s[12:15], s45 offen lds
    s_add_u32 m0, s47, 50176
    s_add_u32 s45, s45, 15360
    buffer_load_dwordx4 v8, s[12:15], s45 offen lds
    s_lshr_b64 s[98:99], s[98:99], 4
    s_and_b32 s46, s98, 15
    s_waitcnt vmcnt(4)
    s_branch L_pc_28
L_pc_27:
    s_waitcnt vmcnt(12)
L_pc_28:
    v_mov_b32 v0, 0
    buffer_load_dword v35, v0, s[20:23], 0 offen sc0 sc1
    s_barrier
    ds_read_b128 v[88:91], v10 offset:0
    ds_read_b64_tr_b16 v[40:41], v18 offset:0
    ds_read_b64_tr_b16 v[42:43], v18 offset:1024
    ds_read_b64_tr_b16 v[44:45], v19 offset:0
    ds_read_b64_tr_b16 v[46:47], v19 offset:1024
    ds_read_b128 v[92:95], v11 offset:0
    ds_read_b64_tr_b16 v[48:49], v18 offset:4096
    ds_read_b64_tr_b16 v[50:51], v18 offset:5120
    ds_read_b64_tr_b16 v[52:53], v19 offset:4096
    ds_read_b64_tr_b16 v[54:55], v19 offset:5120
    ds_read_b128 v[96:99], v12 offset:0
    ds_read_b64_tr_b16 v[248:249], v18 offset:8192
    ds_read_b64_tr_b16 v[250:251], v18 offset:9216
    ds_read_b64_tr_b16 v[252:253], v19 offset:8192
    ds_read_b64_tr_b16 v[254:255], v19 offset:9216
    s_waitcnt lgkmcnt(10)
    v_mfma_f32_32x32x16_bf16 v[56:71], v[88:91], v[40:43], 0
    v_mfma_f32_32x32x16_bf16 v[72:87], v[88:91], v[44:47], 0
    s_add_u32 m0, s47, 65536
    s_lshl_b32 s44, s46, 7
    buffer_load_dwordx4 v6, s[8:11], s44 offen lds
    s_add_u32 m0, s47, 66560
    s_lshl_b32 s44, s46, 7
    buffer_load_dwordx4 v7, s[8:11], s44 offen lds
    ds_read_b128 v[100:103], v13 offset:0
    ds_read_b64_tr_b16 v[40:41], v18 offset:12288
    ds_read_b64_tr_b16 v[42:43], v18 offset:13312
    ds_read_b64_tr_b16 v[44:45], v19 offset:12288
    ds_read_b64_tr_b16 v[46:47], v19 offset:13312
    s_waitcnt lgkmcnt(10)
    v_mfma_f32_32x32x16_bf16 v[56:71], v[92:95], v[48:51], v[56:71]
    v_mfma_f32_32x32x16_bf16 v[72:87], v[92:95], v[52:55], v[72:87]
    s_add_u32 m0, s47, 81920
    s_mul_i32 s45, s46, 245760
    buffer_load_dwordx4 v8, s[12:15], s45 offen lds
    s_add_u32 m0, s47, 82944
    s_add_u32 s45, s45, 15360
    buffer_load_dwordx4 v8, s[12:15], s45 offen lds
    s_lshr_b64 s[98:99], s[98:99], 4
    s_and_b32 s46, s98, 15
    s_cmp_eq_u32 s49, 0
    s_cbranch_scc1 L_es_29
    s_waitcnt vmcnt(13)
    s_branch L_es_30
L_es_29:
    s_waitcnt vmcnt(5)
L_es_30:
    s_barrier
    ds_read_b128 v[104:107], v10 offset:32768
    ds_read_b64_tr_b16 v[48:49], v18 offset:32768
    ds_read_b64_tr_b16 v[50:51], v18 offset:33792
    ds_read_b64_tr_b16 v[52:53], v19 offset:32768
    ds_read_b64_tr_b16 v[54:55], v19 offset:33792
    s_waitcnt lgkmcnt(10)
    v_mfma_f32_32x32x16_bf16 v[56:71], v[96:99], v[248:251], v[56:71]
    v_mfma_f32_32x32x16_bf16 v[72:87], v[96:99], v[252:255], v[72:87]
    s_add_u32 m0, s47, 98304
    s_lshl_b32 s44, s46, 7
    buffer_load_dwordx4 v6, s[8:11], s44 offen lds
    ds_read_b128 v[108:111], v11 offset:32768
    ds_read_b64_tr_b16 v[248:249], v18 offset:36864
    ds_read_b64_tr_b16 v[250:251], v18 offset:37888
    ds_read_b64_tr_b16 v[252:253], v19 offset:36864
    ds_read_b64_tr_b16 v[254:255], v19 offset:37888
    s_waitcnt lgkmcnt(10)
    v_mfma_f32_32x32x16_bf16 v[56:71], v[100:103], v[40:43], v[56:71]
    v_mfma_f32_32x32x16_bf16 v[72:87], v[100:103], v[44:47], v[72:87]
    s_add_u32 m0, s47, 99328
    s_lshl_b32 s44, s46, 7
    buffer_load_dwordx4 v7, s[8:11], s44 offen lds
    ds_read_b128 v[112:115], v12 offset:32768
    ds_read_b64_tr_b16 v[40:41], v18 offset:40960
    ds_read_b64_tr_b16 v[42:43], v18 offset:41984
    ds_read_b64_tr_b16 v[44:45], v19 offset:40960
    ds_read_b64_tr_b16 v[46:47], v19 offset:41984
    s_waitcnt lgkmcnt(10)
    v_mfma_f32_32x32x16_bf16 v[56:71], v[104:107], v[48:51], v[56:71]
    v_mfma_f32_32x32x16_bf16 v[72:87], v[104:107], v[52:55], v[72:87]
    s_add_u32 m0, s47, 114688
    s_mul_i32 s45, s46, 245760
    buffer_load_dwordx4 v8, s[12:15], s45 offen lds
    ds_read_b128 v[116:119], v13 offset:32768
    ds_read_b64_tr_b16 v[48:49], v18 offset:45056
    ds_read_b64_tr_b16 v[50:51], v18 offset:46080
    ds_read_b64_tr_b16 v[52:53], v19 offset:45056
    ds_read_b64_tr_b16 v[54:55], v19 offset:46080
    s_waitcnt lgkmcnt(10)
    v_mfma_f32_32x32x16_bf16 v[56:71], v[108:111], v[248:251], v[56:71]
    v_mfma_f32_32x32x16_bf16 v[72:87], v[108:111], v[252:255], v[72:87]
    s_add_u32 m0, s47, 115712
    s_add_u32 s45, s45, 15360
    buffer_load_dwordx4 v8, s[12:15], s45 offen lds
    s_lshr_b64 s[98:99], s[98:99], 4
    s_and_b32 s46, s98, 15
    s_waitcnt vmcnt(4)
    s_barrier
    ds_read_b128 v[120:123], v14 offset:0
    ds_read_b64_tr_b16 v[248:249], v20 offset:0
    ds_read_b64_tr_b16 v[250:251], v20 offset:1024
    ds_read_b64_tr_b16 v[252:253], v21 offset:0
    ds_read_b64_tr_b16 v[254:255], v21 offset:1024
    v_readfirstlane_b32 s60, v35
    s_max_u32 s43, s43, s60
    s_cmp_eq_u32 s49, 0
    s_cbranch_scc1 L_pa_31
    s_cmp_lg_u32 s43, 0
    s_cbranch_scc1 L_ngd_33
    v_mov_b32 v0, 0
    s_mov_b32 s62, 0x200000
L_ng_32:
    buffer_load_dword v1, v0, s[20:23], 0 offen sc0 sc1
    s_waitcnt vmcnt(0)
    v_readfirstlane_b32 s43, v1
    s_cmp_lg_u32 s43, 0
    s_cbranch_scc1 L_ngd_33
    s_sleep 8
    s_sub_u32 s62, s62, 1
    s_cmp_lg_u32 s62, 0
    s_cbranch_scc1 L_ng_32
L_ngd_33:
    s_lshl_b32 s60, s52, 5
    s_add_u32 s60, s60, s53
    s_lshl_b32 s60, s60, 4
    s_add_u32 s60, s60, 10698752
    v_mov_b32 v0, 0
    v_mov_b32 v1, s43
    s_mov_b64 exec, 1
    buffer_store_dword v1, v0, s[16:19], s60 offen sc0 sc1
    s_mov_b64 exec, -1
L_pa_31:
    s_waitcnt lgkmcnt(10)
    v_mfma_f32_32x32x16_bf16 v[56:71], v[112:115], v[40:43], v[56:71]
    v_mfma_f32_32x32x16_bf16 v[72:87], v[112:115], v[44:47], v[72:87]
    s_add_u32 m0, s47, 0
    s_lshl_b32 s44, s46, 7
    buffer_load_dwordx4 v6, s[8:11], s44 offen lds
    ds_read_b128 v[124:127], v15 offset:0
    ds_read_b64_tr_b16 v[40:41], v20 offset:4096
    ds_read_b64_tr_b16 v[42:43], v20 offset:5120
    ds_read_b64_tr_b16 v[44:45], v21 offset:4096
    ds_read_b64_tr_b16 v[46:47], v21 offset:5120
    s_waitcnt lgkmcnt(10)
    v_mfma_f32_32x32x16_bf16 v[56:71], v[116:119], v[48:51], v[56:71]
    v_mfma_f32_32x32x16_bf16 v[72:87], v[116:119], v[52:55], v[72:87]
    s_add_u32 m0, s47, 1024
    s_lshl_b32 s44, s46, 7
    buffer_load_dwordx4 v7, s[8:11], s44 offen lds
    ds_read_b128 v[128:131], v16 offset:0
    ds_read_b64_tr_b16 v[48:49], v20 offset:8192
    ds_read_b64_tr_b16 v[50:51], v20 offset:9216
    ds_read_b64_tr_b16 v[52:53], v21 offset:8192
    ds_read_b64_tr_b16 v[54:55], v21 offset:9216
    s_waitcnt lgkmcnt(10)
    v_mfma_f32_32x32x16_bf16 v[56:71], v[120:123], v[248:251], v[56:71]
    v_mfma_f32_32x32x16_bf16 v[72:87], v[120:123], v[252:255], v[72:87]
    s_add_u32 m0, s47, 16384
    s_mul_i32 s45, s46, 245760
    buffer_load_dwordx4 v8, s[12:15], s45 offen lds
    ds_read_b128 v[132:135], v17 offset:0
    ds_read_b64_tr_b16 v[248:249], v20 offset:12288
    ds_read_b64_tr_b16 v[250:251], v20 offset:13312
    ds_read_b64_tr_b16 v[252:253], v21 offset:12288
    ds_read_b64_tr_b16 v[254:255], v21 offset:13312
    s_waitcnt lgkmcnt(10)
    v_mfma_f32_32x32x16_bf16 v[56:71], v[124:127], v[40:43], v[56:71]
    v_mfma_f32_32x32x16_bf16 v[72:87], v[124:127], v[44:47], v[72:87]
    s_add_u32 m0, s47, 17408
    s_add_u32 s45, s45, 15360
    buffer_load_dwordx4 v8, s[12:15], s45 offen lds
    s_lshr_b64 s[98:99], s[98:99], 4
    s_and_b32 s46, s98, 15
    s_cmp_eq_u32 s49, 0
    s_cbranch_scc1 L_es_34
    s_waitcnt vmcnt(5)
    s_branch L_es_35
L_es_34:
    s_waitcnt vmcnt(4)
L_es_35:
    s_barrier
    ds_read_b128 v[136:139], v14 offset:32768
    ds_read_b64_tr_b16 v[40:41], v20 offset:32768
    ds_read_b64_tr_b16 v[42:43], v20 offset:33792
    ds_read_b64_tr_b16 v[44:45], v21 offset:32768
    ds_read_b64_tr_b16 v[46:47], v21 offset:33792
    s_waitcnt lgkmcnt(10)
    v_mfma_f32_32x32x16_bf16 v[56:71], v[128:131], v[48:51], v[56:71]
    v_mfma_f32_32x32x16_bf16 v[72:87], v[128:131], v[52:55], v[72:87]
    s_add_u32 m0, s47, 32768
    s_lshl_b32 s44, s46, 7
    buffer_load_dwordx4 v6, s[8:11], s44 offen lds
    ds_read_b128 v[140:143], v15 offset:32768
    ds_read_b64_tr_b16 v[48:49], v20 offset:36864
    ds_read_b64_tr_b16 v[50:51], v20 offset:37888
    ds_read_b64_tr_b16 v[52:53], v21 offset:36864
    ds_read_b64_tr_b16 v[54:55], v21 offset:37888
    s_waitcnt lgkmcnt(10)
    v_mfma_f32_32x32x16_bf16 v[56:71], v[132:135], v[248:251], v[56:71]
    v_mfma_f32_32x32x16_bf16 v[72:87], v[132:135], v[252:255], v[72:87]
    s_add_u32 m0, s47, 33792
    s_lshl_b32 s44, s46, 7
    buffer_load_dwordx4 v7, s[8:11], s44 offen lds
    ds_read_b128 v[144:147], v16 offset:32768
    ds_read_b64_tr_b16 v[248:249], v20 offset:40960
    ds_read_b64_tr_b16 v[250:251], v20 offset:41984
    ds_read_b64_tr_b16 v[252:253], v21 offset:40960
    ds_read_b64_tr_b16 v[254:255], v21 offset:41984
    s_waitcnt lgkmcnt(10)
    v_mfma_f32_32x32x16_bf16 v[56:71], v[136:139], v[40:43], v[56:71]
    v_mfma_f32_32x32x16_bf16 v[72:87], v[136:139], v[44:47], v[72:87]
    s_add_u32 m0, s47, 49152
    s_mul_i32 s45, s46, 245760
    buffer_load_dwordx4 v8, s[12:15], s45 offen lds
    ds_read_b128 v[148:151], v17 offset:32768
    ds_read_b64_tr_b16 v[40:41], v20 offset:45056
    ds_read_b64_tr_b16 v[42:43], v20 offset:46080
    ds_read_b64_tr_b16 v[44:45], v21 offset:45056
    ds_read_b64_tr_b16 v[46:47], v21 offset:46080
    s_waitcnt lgkmcnt(10)
    v_mfma_f32_32x32x16_bf16 v[56:71], v[140:143], v[48:51], v[56:71]
    v_mfma_f32_32x32x16_bf16 v[72:87], v[140:143], v[52:55], v[72:87]
    s_add_u32 m0, s47, 50176
    s_add_u32 s45, s45, 15360
    buffer_load_dwordx4 v8, s[12:15], s45 offen lds
    s_lshr_b64 s[98:99], s[98:99], 4
    s_and_b32 s46, s98, 15
    s_waitcnt vmcnt(4)
    s_barrier
    ds_read_b128 v[152:155], v10 offset:0
    ds_read_b64_tr_b16 v[48:49], v18 offset:0
    ds_read_b64_tr_b16 v[50:51], v18 offset:1024
    ds_read_b64_tr_b16 v[52:53], v19 offset:0
    ds_read_b64_tr_b16 v[54:55], v19 offset:1024
    s_waitcnt lgkmcnt(10)
    v_mfma_f32_32x32x16_bf16 v[56:71], v[144:147], v[248:251], v[56:71]
    v_mfma_f32_32x32x16_bf16 v[72:87], v[144:147], v[252:255], v[72:87]
    s_add_u32 m0, s47, 65536
    s_lshl_b32 s44, s46, 7
    buffer_load_dwordx4 v6, s[8:11], s44 offen lds
    ds_read_b128 v[156:159], v11 offset:0
    ds_read_b64_tr_b16 v[248:249], v18 offset:4096
    ds_read_b64_tr_b16 v[250:251], v18 offset:5120
    ds_read_b64_tr_b16 v[252:253], v19 offset:4096
    ds_read_b64_tr_b16 v[254:255], v19 offset:5120
    s_waitcnt lgkmcnt(10)
    v_mfma_f32_32x32x16_bf16 v[56:71], v[148:151], v[40:43], v[56:71]
    v_mfma_f32_32x32x16_bf16 v[72:87], v[148:151], v[44:47], v[72:87]
    s_add_u32 m0, s47, 66560
    s_lshl_b32 s44, s46, 7
    buffer_load_dwordx4 v7, s[8:11], s44 offen lds
    ds_read_b128 v[160:163], v12 offset:0
    ds_read_b64_tr_b16 v[40:41], v18 offset:8192
    ds_read_b64_tr_b16 v[42:43], v18 offset:9216
    ds_read_b64_tr_b16 v[44:45], v19 offset:8192
    ds_read_b64_tr_b16 v[46:47], v19 offset:9216
    s_waitcnt lgkmcnt(10)
    v_mfma_f32_32x32x16_bf16 v[56:71], v[152:155], v[48:51], v[56:71]
    v_mfma_f32_32x32x16_bf16 v[72:87], v[152:155], v[52:55], v[72:87]
    s_add_u32 m0, s47, 81920
    s_mul_i32 s45, s46, 245760
    buffer_load_dwordx4 v8, s[12:15], s45 offen lds
    ds_read_b128 v[164:167], v13 offset:0
    ds_read_b64_tr_b16 v[48:49], v18 offset:12288
    ds_read_b64_tr_b16 v[50:51], v18 offset:13312
    ds_read_b64_tr_b16 v[52:53], v19 offset:12288
    ds_read_b64_tr_b16 v[54:55], v19 offset:13312
    s_waitcnt lgkmcnt(10)
    v_mfma_f32_32x32x16_bf16 v[56:71], v[156:159], v[248:251], v[56:71]
    v_mfma_f32_32x32x16_bf16 v[72:87], v[156:159], v[252:255], v[72:87]
    s_add_u32 m0, s47, 82944
    s_add_u32 s45, s45, 15360
    buffer_load_dwordx4 v8, s[12:15], s45 offen lds
    s_lshr_b64 s[98:99], s[98:99], 4
    s_and_b32 s46, s98, 15
    s_waitcnt vmcnt(4)
    s_barrier
    ds_read_b128 v[168:171], v10 offset:32768
    ds_read_b64_tr_b16 v[248:249], v18 offset:32768
    ds_read_b64_tr_b16 v[250:251], v18 offset:33792
    ds_read_b64_tr_b16 v[252:253], v19 offset:32768
    ds_read_b64_tr_b16 v[254:255], v19 offset:33792
    s_waitcnt lgkmcnt(10)
    v_mfma_f32_32x32x16_bf16 v[56:71], v[160:163], v[40:43], v[56:71]
    v_mfma_f32_32x32x16_bf16 v[72:87], v[160:163], v[44:47], v[72:87]
    s_add_u32 m0, s47, 98304
    s_lshl_b32 s44, s46, 7
    buffer_load_dwordx4 v6, s[8:11], s44 offen lds
    ds_read_b128 v[172:175], v11 offset:32768
    ds_read_b64_tr_b16 v[40:41], v18 offset:36864
    ds_read_b64_tr_b16 v[42:43], v18 offset:37888
    ds_read_b64_tr_b16 v[44:45], v19 offset:36864
    ds_read_b64_tr_b16 v[46:47], v19 offset:37888
    s_waitcnt lgkmcnt(10)
    v_mfma_f32_32x32x16_bf16 v[56:71], v[164:167], v[48:51], v[56:71]
    v_mfma_f32_32x32x16_bf16 v[72:87], v[164:167], v[52:55], v[72:87]
    s_add_u32 m0, s47, 99328
    s_lshl_b32 s44, s46, 7
    buffer_load_dwordx4 v7, s[8:11], s44 offen lds
    ds_read_b128 v[176:179], v12 offset:32768
    ds_read_b64_tr_b16 v[48:49], v18 offset:40960
    ds_read_b64_tr_b16 v[50:51], v18 offset:41984
    ds_read_b64_tr_b16 v[52:53], v19 offset:40960
    ds_read_b64_tr_b16 v[54:55], v19 offset:41984
    s_waitcnt lgkmcnt(10)
    v_mfma_f32_32x32x16_bf16 v[56:71], v[168:171], v[248:251], v[56:71]
    v_mfma_f32_32x32x16_bf16 v[72:87], v[168:171], v[252:255], v[72:87]
    s_add_u32 m0, s47, 114688
    s_mul_i32 s45, s46, 245760
    buffer_load_dwordx4 v8, s[12:15], s45 offen lds
    ds_read_b128 v[180:183], v13 offset:32768
    ds_read_b64_tr_b16 v[248:249], v18 offset:45056
    ds_read_b64_tr_b16 v[250:251], v18 offset:46080
    ds_read_b64_tr_b16 v[252:253], v19 offset:45056
    ds_read_b64_tr_b16 v[254:255], v19 offset:46080
    s_waitcnt lgkmcnt(10)
    v_mfma_f32_32x32x16_bf16 v[56:71], v[172:175], v[40:43], v[56:71]
    v_mfma_f32_32x32x16_bf16 v[72:87], v[172:175], v[44:47], v[72:87]
    s_add_u32 m0, s47, 115712
    s_add_u32 s45, s45, 15360
    buffer_load_dwordx4 v8, s[12:15], s45 offen lds
    s_lshr_b64 s[98:99], s[98:99], 4
    s_and_b32 s46, s98, 15
    s_waitcnt vmcnt(4)
    s_barrier
    ds_read_b128 v[184:187], v14 offset:0
    ds_read_b64_tr_b16 v[40:41], v20 offset:0
    ds_read_b64_tr_b16 v[42:43], v20 offset:1024
    ds_read_b64_tr_b16 v[44:45], v21 offset:0
    ds_read_b64_tr_b16 v[46:47], v21 offset:1024
    s_cmp_lg_u32 s38, 7
    s_cbranch_scc1 L_pw_36
    s_lshl_b32 s60, s40, 9
    s_add_u32 s60, s60, 10698752
    v_min_u32 v0, 19, v2
    v_lshlrev_b32 v0, 4, v0
    buffer_load_dword v34, v0, s[16:19], s60 offen sc0 sc1
L_pw_36:
    s_waitcnt lgkmcnt(10)
    v_mfma_f32_32x32x16_bf16 v[56:71], v[176:179], v[48:51], v[56:71]
    v_mfma_f32_32x32x16_bf16 v[72:87], v[176:179], v[52:55], v[72:87]
    s_add_u32 m0, s47, 0
    s_lshl_b32 s44, s46, 7
    buffer_load_dwordx4 v6, s[8:11], s44 offen lds
    ds_read_b128 v[188:191], v15 offset:0
    ds_read_b64_tr_b16 v[48:49], v20 offset:4096
    ds_read_b64_tr_b16 v[50:51], v20 offset:5120
    ds_read_b64_tr_b16 v[52:53], v21 offset:4096
    ds_read_b64_tr_b16 v[54:55], v21 offset:5120
    s_waitcnt lgkmcnt(10)
    v_mfma_f32_32x32x16_bf16 v[56:71], v[180:183], v[248:251], v[56:71]
    v_mfma_f32_32x32x16_bf16 v[72:87], v[180:183], v[252:255], v[72:87]
    s_add_u32 m0, s47, 1024
    s_lshl_b32 s44, s46, 7
    buffer_load_dwordx4 v7, s[8:11], s44 offen lds
    ds_read_b128 v[192:195], v16 offset:0
    ds_read_b64_tr_b16 v[248:249], v20 offset:8192
    ds_read_b64_tr_b16 v[250:251], v20 offset:9216
    ds_read_b64_tr_b16 v[252:253], v21 offset:8192
    ds_read_b64_tr_b16 v[254:255], v21 offset:9216
    s_waitcnt lgkmcnt(10)
    v_mfma_f32_32x32x16_bf16 v[56:71], v[184:187], v[40:43], v[56:71]
    v_mfma_f32_32x32x16_bf16 v[72:87], v[184:187], v[44:47], v[72:87]
    s_add_u32 m0, s47, 16384
    s_mul_i32 s45, s46, 245760
    buffer_load_dwordx4 v8, s[12:15], s45 offen lds
    ds_read_b128 v[196:199], v17 offset:0
    ds_read_b64_tr_b16 v[40:41], v20 offset:12288
    ds_read_b64_tr_b16 v[42:43], v20 offset:13312
    ds_read_b64_tr_b16 v[44:45], v21 offset:12288
    ds_read_b64_tr_b16 v[46:47], v21 offset:13312
    s_waitcnt lgkmcnt(10)
    v_mfma_f32_32x32x16_bf16 v[56:71], v[188:191], v[48:51], v[56:71]
    v_mfma_f32_32x32x16_bf16 v[72:87], v[188:191], v[52:55], v[72:87]
    s_add_u32 m0, s47, 17408
    s_add_u32 s45, s45, 15360
    buffer_load_dwordx4 v8, s[12:15], s45 offen lds
    s_lshr_b64 s[98:99], s[98:99], 4
    s_and_b32 s46, s98, 15
    s_waitcnt vmcnt(4)
    s_barrier
    ds_read_b128 v[200:203], v14 offset:32768
    ds_read_b64_tr_b16 v[48:49], v20 offset:32768
    ds_read_b64_tr_b16 v[50:51], v20 offset:33792
    ds_read_b64_tr_b16 v[52:53], v21 offset:32768
    ds_read_b64_tr_b16 v[54:55], v21 offset:33792
    s_waitcnt lgkmcnt(10)
    v_mfma_f32_32x32x16_bf16 v[56:71], v[192:195], v[248:251], v[56:71]
    v_mfma_f32_32x32x16_bf16 v[72:87], v[192:195], v[252:255], v[72:87]
    s_add_u32 m0, s47, 32768
    s_lshl_b32 s44, s46, 7
    buffer_load_dwordx4 v6, s[8:11], s44 offen lds
    ds_read_b128 v[204:207], v15 offset:32768
    ds_read_b64_tr_b16 v[248:249], v20 offset:36864
    ds_read_b64_tr_b16 v[250:251], v20 offset:37888
    ds_read_b64_tr_b16 v[252:253], v21 offset:36864
    ds_read_b64_tr_b16 v[254:255], v21 offset:37888
    s_waitcnt lgkmcnt(10)
    v_mfma_f32_32x32x16_bf16 v[56:71], v[196:199], v[40:43], v[56:71]
    v_mfma_f32_32x32x16_bf16 v[72:87], v[196:199], v[44:47], v[72:87]
    s_add_u32 m0, s47, 33792
    s_lshl_b32 s44, s46, 7
    buffer_load_dwordx4 v7, s[8:11], s44 offen lds
    ds_read_b128 v[208:211], v16 offset:32768
    ds_read_b64_tr_b16 v[40:41], v20 offset:40960
    ds_read_b64_tr_b16 v[42:43], v20 offset:41984
    ds_read_b64_tr_b16 v[44:45], v21 offset:40960
    ds_read_b64_tr_b16 v[46:47], v21 offset:41984
    s_waitcnt lgkmcnt(10)
    v_mfma_f32_32x32x16_bf16 v[56:71], v[200:203], v[48:51], v[56:71]
    v_mfma_f32_32x32x16_bf16 v[72:87], v[200:203], v[52:55], v[72:87]
    s_add_u32 m0, s47, 49152
    s_mul_i32 s45, s46, 245760
    buffer_load_dwordx4 v8, s[12:15], s45 offen lds
    ds_read_b128 v[212:215], v17 offset:32768
    ds_read_b64_tr_b16 v[48:49], v20 offset:45056
    ds_read_b64_tr_b16 v[50:51], v20 offset:46080
    ds_read_b64_tr_b16 v[52:53], v21 offset:45056
    ds_read_b64_tr_b16 v[54:55], v21 offset:46080
    s_waitcnt lgkmcnt(10)
    v_mfma_f32_32x32x16_bf16 v[56:71], v[204:207], v[248:251], v[56:71]
    v_mfma_f32_32x32x16_bf16 v[72:87], v[204:207], v[252:255], v[72:87]
    s_add_u32 m0, s47, 50176
    s_add_u32 s45, s45, 15360
    buffer_load_dwordx4 v8, s[12:15], s45 offen lds
    s_mov_b64 s[98:99], s[100:101]
    s_and_b32 s46, s98, 15
    s_waitcnt vmcnt(4)
    s_cmp_lg_u32 s38, 7
    s_cbranch_scc1 L_pw_37
    v_cmp_ne_u32 vcc, s43, v34
    s_cmp_eq_u32 s43, 0
    s_cselect_b32 s60, 1, 0
    s_nop 2
    s_and_b32 s61, vcc_lo, 0xfffff
    s_or_b32 s60, s60, s61
    s_cbranch_scc0 L_pw_37
    s_cmp_lg_u32 s43, 0
    s_cbranch_scc1 L_ngd_39
    v_mov_b32 v0, 0
    s_mov_b32 s62, 0x200000
L_ng_38:
    buffer_load_dword v1, v0, s[20:23], 0 offen sc0 sc1
    s_waitcnt vmcnt(0)
    v_readfirstlane_b32 s43, v1
    s_cmp_lg_u32 s43, 0
    s_cbranch_scc1 L_ngd_39
    s_sleep 8
    s_sub_u32 s62, s62, 1
    s_cmp_lg_u32 s62, 0
    s_cbranch_scc1 L_ng_38
L_ngd_39:
    s_lshl_b32 s60, s40, 9
    s_add_u32 s60, s60, 10698752
    v_min_u32 v0, 19, v2
    v_lshlrev_b32 v0, 4, v0
    s_mov_b32 s62, 0x200000
L_fw_40:
    buffer_load_dword v1, v0, s[16:19], s60 offen sc0 sc1
    s_waitcnt vmcnt(0)
    v_cmp_ne_u32 vcc, s43, v1
    s_nop 3
    s_cmp_eq_u64 vcc, 0
    s_cbranch_scc1 L_fwd_41
    s_sleep 10
    s_sub_u32 s62, s62, 1
    s_cmp_lg_u32 s62, 0
    s_cbranch_scc1 L_fw_40
L_fwd_41:
L_pw_37:
    s_barrier
    ds_read_b128 v[216:219], v10 offset:0
    ds_read_b64_tr_b16 v[248:249], v18 offset:0
    ds_read_b64_tr_b16 v[250:251], v18 offset:1024
    ds_read_b64_tr_b16 v[252:253], v19 offset:0
    ds_read_b64_tr_b16 v[254:255], v19 offset:1024
    s_waitcnt lgkmcnt(10)
    v_mfma_f32_32x32x16_bf16 v[56:71], v[208:211], v[40:43], v[56:71]
    v_mfma_f32_32x32x16_bf16 v[72:87], v[208:211], v[44:47], v[72:87]
    s_lshl_b32 s45, s46, 14
    s_add_u32 m0, s47, 131072
    s_add_u32 s45, s45, s50
    buffer_load_dwordx4 v3, s[16:19], s45 offen sc1 lds
    s_add_u32 m0, s47, 132096
    s_add_u32 s45, s45, 1024
    buffer_load_dwordx4 v3, s[16:19], s45 offen sc1 lds
    s_lshr_b64 s[98:99], s[98:99], 4
    s_and_b32 s46, s98, 15
    ds_read_b128 v[220:223], v11 offset:0
    ds_read_b64_tr_b16 v[40:41], v18 offset:4096
    ds_read_b64_tr_b16 v[42:43], v18 offset:5120
    ds_read_b64_tr_b16 v[44:45], v19 offset:4096
    ds_read_b64_tr_b16 v[46:47], v19 offset:5120
    s_waitcnt lgkmcnt(10)
    v_mfma_f32_32x32x16_bf16 v[56:71], v[212:215], v[48:51], v[56:71]
    v_mfma_f32_32x32x16_bf16 v[72:87], v[212:215], v[52:55], v[72:87]
    s_lshl_b32 s45, s46, 14
    s_add_u32 m0, s47, 147456
    s_add_u32 s45, s45, s50
    buffer_load_dwordx4 v3, s[16:19], s45 offen sc1 lds
    s_add_u32 m0, s47, 148480
    s_add_u32 s45, s45, 1024
    buffer_load_dwordx4 v3, s[16:19], s45 offen sc1 lds
    s_lshr_b64 s[98:99], s[98:99], 4
    s_and_b32 s46, s98, 15
    ds_read_b128 v[224:227], v12 offset:0
    ds_read_b64_tr_b16 v[48:49], v18 offset:8192
    ds_read_b64_tr_b16 v[50:51], v18 offset:9216
    ds_read_b64_tr_b16 v[52:53], v19 offset:8192
    ds_read_b64_tr_b16 v[54:55], v19 offset:9216
    s_waitcnt lgkmcnt(10)
    v_mfma_f32_32x32x16_bf16 v[56:71], v[216:219], v[248:251], v[56:71]
    v_mfma_f32_32x32x16_bf16 v[72:87], v[216:219], v[252:255], v[72:87]
    s_lshl_b32 s45, s46, 14
    s_add_u32 m0, s47, 65536
    s_add_u32 s45, s45, s50
    buffer_load_dwordx4 v3, s[16:19], s45 offen sc1 lds
    s_add_u32 m0, s47, 66560
    s_add_u32 s45, s45, 1024
    buffer_load_dwordx4 v3, s[16:19], s45 offen sc1 lds
    s_lshr_b64 s[98:99], s[98:99], 4
    s_and_b32 s46, s98, 15
    ds_read_b128 v[228:231], v13 offset:0
    ds_read_b64_tr_b16 v[248:249], v18 offset:12288
    ds_read_b64_tr_b16 v[250:251], v18 offset:13312
    ds_read_b64_tr_b16 v[252:253], v19 offset:12288
    ds_read_b64_tr_b16 v[254:255], v19 offset:13312
    s_waitcnt lgkmcnt(10)
    v_mfma_f32_32x32x16_bf16 v[56:71], v[220:223], v[40:43], v[56:71]
    v_mfma_f32_32x32x16_bf16 v[72:87], v[220:223], v[44:47], v[72:87]
    s_waitcnt vmcnt(6)
    s_barrier
    ds_read_b128 v[232:235], v10 offset:32768
    ds_read_b64_tr_b16 v[40:41], v18 offset:32768
    ds_read_b64_tr_b16 v[42:43], v18 offset:33792
    ds_read_b64_tr_b16 v[44:45], v19 offset:32768
    ds_read_b64_tr_b16 v[46:47], v19 offset:33792
    s_waitcnt lgkmcnt(10)
    v_mfma_f32_32x32x16_bf16 v[56:71], v[224:227], v[48:51], v[56:71]
    v_mfma_f32_32x32x16_bf16 v[72:87], v[224:227], v[52:55], v[72:87]
    s_lshl_b32 s45, s46, 14
    s_add_u32 m0, s47, 82432
    s_add_u32 s45, s45, s50
    buffer_load_dwordx4 v3, s[16:19], s45 offen sc1 lds
    ds_read_b128 v[236:239], v11 offset:32768
    ds_read_b64_tr_b16 v[48:49], v18 offset:36864
    ds_read_b64_tr_b16 v[50:51], v18 offset:37888
    ds_read_b64_tr_b16 v[52:53], v19 offset:36864
    ds_read_b64_tr_b16 v[54:55], v19 offset:37888
    s_waitcnt lgkmcnt(10)
    v_mfma_f32_32x32x16_bf16 v[56:71], v[228:231], v[248:251], v[56:71]
    v_mfma_f32_32x32x16_bf16 v[72:87], v[228:231], v[252:255], v[72:87]
    s_add_u32 m0, s47, 83456
    s_add_u32 s45, s45, 1024
    buffer_load_dwordx4 v3, s[16:19], s45 offen sc1 lds
    s_lshr_b64 s[98:99], s[98:99], 4
    s_and_b32 s46, s98, 15
    ds_read_b128 v[240:243], v12 offset:32768
    ds_read_b64_tr_b16 v[248:249], v18 offset:40960
    ds_read_b64_tr_b16 v[250:251], v18 offset:41984
    ds_read_b64_tr_b16 v[252:253], v19 offset:40960
    ds_read_b64_tr_b16 v[254:255], v19 offset:41984
    s_waitcnt lgkmcnt(10)
    v_mfma_f32_32x32x16_bf16 v[56:71], v[232:235], v[40:43], v[56:71]
    v_mfma_f32_32x32x16_bf16 v[72:87], v[232:235], v[44:47], v[72:87]
    s_lshl_b32 s45, s46, 14
    s_add_u32 m0, s47, 98816
    s_add_u32 s45, s45, s50
    buffer_load_dwordx4 v3, s[16:19], s45 offen sc1 lds
    ds_read_b128 v[244:247], v13 offset:32768
    ds_read_b64_tr_b16 v[40:41], v18 offset:45056
    ds_read_b64_tr_b16 v[42:43], v18 offset:46080
    ds_read_b64_tr_b16 v[44:45], v19 offset:45056
    ds_read_b64_tr_b16 v[46:47], v19 offset:46080
    s_waitcnt lgkmcnt(10)
    v_mfma_f32_32x32x16_bf16 v[56:71], v[236:239], v[48:51], v[56:71]
    v_mfma_f32_32x32x16_bf16 v[72:87], v[236:239], v[52:55], v[72:87]
    s_add_u32 m0, s47, 99840
    s_add_u32 s45, s45, 1024
    buffer_load_dwordx4 v3, s[16:19], s45 offen sc1 lds
    s_lshr_b64 s[98:99], s[98:99], 4
    s_and_b32 s46, s98, 15
    s_waitcnt vmcnt(6)
    s_barrier
    ds_read_b128 v[48:51], v23 offset:0
    ds_read_b128 v[52:55], v23 offset:1024
    s_waitcnt lgkmcnt(7)
    v_mfma_f32_32x32x16_bf16 v[56:71], v[240:243], v[248:251], v[56:71]
    v_mfma_f32_32x32x16_bf16 v[72:87], v[240:243], v[252:255], v[72:87]
    s_lshl_b32 s45, s46, 14
    s_add_u32 m0, s47, 0
    s_add_u32 s45, s45, s50
    buffer_load_dwordx4 v3, s[16:19], s45 offen sc1 lds
    ds_read_b128 v[248:251], v23 offset:4096
    ds_read_b128 v[252:255], v23 offset:5120
    s_waitcnt lgkmcnt(4)
    v_mfma_f32_32x32x16_bf16 v[56:71], v[244:247], v[40:43], v[56:71]
    v_mfma_f32_32x32x16_bf16 v[72:87], v[244:247], v[44:47], v[72:87]
    s_add_u32 m0, s47, 1024
    s_add_u32 s45, s45, 1024
    buffer_load_dwordx4 v3, s[16:19], s45 offen sc1 lds
    s_lshr_b64 s[98:99], s[98:99], 4
    s_and_b32 s46, s98, 15
    s_nop 7
    s_nop 3
L_p1_cv:
    s_nop 3
    v_cvt_pk_bf16_f32 v8, v56, v57
    v_cvt_pk_bf16_f32 v9, v58, v59
    v_cvt_pk_bf16_f32 v10, v60, v61
    v_cvt_pk_bf16_f32 v11, v62, v63
    v_cvt_pk_bf16_f32 v12, v64, v65
    v_cvt_pk_bf16_f32 v13, v66, v67
    v_cvt_pk_bf16_f32 v14, v68, v69
    v_cvt_pk_bf16_f32 v15, v70, v71
    v_cvt_pk_bf16_f32 v16, v72, v73
    v_cvt_pk_bf16_f32 v17, v74, v75
    v_cvt_pk_bf16_f32 v18, v76, v77
    v_cvt_pk_bf16_f32 v19, v78, v79
    v_cvt_pk_bf16_f32 v32, v80, v81
    v_cvt_pk_bf16_f32 v33, v82, v83
    v_cvt_pk_bf16_f32 v34, v84, v85
    v_cvt_pk_bf16_f32 v35, v86, v87
L_p2:
    v_add_u32 v20, 0xffff0000, v22
    ds_read_b128 v[40:43], v23 offset:8192
    ds_read_b128 v[44:47], v23 offset:9216
    s_waitcnt lgkmcnt(4)
    v_mfma_f32_32x32x16_bf16 v[56:71], v[48:51], v[88:91], 0
    v_mfma_f32_32x32x16_bf16 v[72:87], v[52:55], v[88:91], 0
    s_cmp_eq_u64 s[4:5], 0
    s_cbranch_scc1 L_sp_0
    s_mov_b64 exec, s[4:5]
    v_mov_b64 v[0:1], v[10:11]
    v_mov_b32_dpp v10, v8 row_half_mirror row_mask:0xf bank_mask:0x5
    v_mov_b32_dpp v11, v9 row_half_mirror row_mask:0xf bank_mask:0x5
    v_mov_b32_dpp v8, v0 row_half_mirror row_mask:0xf bank_mask:0xa
    v_mov_b32_dpp v9, v1 row_half_mirror row_mask:0xf bank_mask:0xa
    s_mov_b64 exec, -1
L_sp_0:
    buffer_store_dwordx4 v[8:11], v24, s[16:19], 0 offen sc1
    ds_read_b128 v[48:51], v23 offset:12288
    ds_read_b128 v[52:55], v23 offset:13312
    s_waitcnt lgkmcnt(4)
    v_mfma_f32_32x32x16_bf16 v[56:71], v[248:251], v[92:95], v[56:71]
    v_mfma_f32_32x32x16_bf16 v[72:87], v[252:255], v[92:95], v[72:87]
    ds_read_b128 v[248:251], v23 offset:16384
    ds_read_b128 v[252:255], v23 offset:17408
    s_waitcnt lgkmcnt(4)
    v_mfma_f32_32x32x16_bf16 v[56:71], v[40:43], v[96:99], v[56:71]
    v_mfma_f32_32x32x16_bf16 v[72:87], v[44:47], v[96:99], v[72:87]
    ds_read_b128 v[40:43], v23 offset:20480
    ds_read_b128 v[44:47], v23 offset:21504
    s_waitcnt lgkmcnt(4)
    v_mfma_f32_32x32x16_bf16 v[56:71], v[48:51], v[100:103], v[56:71]
    v_mfma_f32_32x32x16_bf16 v[72:87], v[52:55], v[100:103], v[72:87]
    ds_read_b128 v[48:51], v23 offset:24576
    ds_read_b128 v[52:55], v23 offset:25600
    s_waitcnt lgkmcnt(4)
    v_mfma_f32_32x32x16_bf16 v[56:71], v[248:251], v[104:107], v[56:71]
    v_mfma_f32_32x32x16_bf16 v[72:87], v[252:255], v[104:107], v[72:87]
    s_cmp_eq_u64 s[6:7], 0
    s_cbranch_scc1 L_sp_1
    s_mov_b64 exec, s[6:7]
    v_mov_b64 v[0:1], v[14:15]
    v_mov_b32_dpp v14, v12 row_half_mirror row_mask:0xf bank_mask:0x5
    v_mov_b32_dpp v15, v13 row_half_mirror row_mask:0xf bank_mask:0x5
    v_mov_b32_dpp v12, v0 row_half_mirror row_mask:0xf bank_mask:0xa
    v_mov_b32_dpp v13, v1 row_half_mirror row_mask:0xf bank_mask:0xa
    s_mov_b64 exec, -1
L_sp_1:
    buffer_store_dwordx4 v[12:15], v25, s[16:19], 0 offen sc1
    ds_read_b128 v[248:251], v23 offset:28672
    ds_read_b128 v[252:255], v23 offset:29696
    s_waitcnt lgkmcnt(4)
    v_mfma_f32_32x32x16_bf16 v[56:71], v[40:43], v[108:111], v[56:71]
    v_mfma_f32_32x32x16_bf16 v[72:87], v[44:47], v[108:111], v[72:87]
    s_waitcnt vmcnt(2)
    s_barrier
    ds_read_b128 v[40:43], v22 offset:0
    ds_read_b128 v[44:47], v22 offset:1024
    s_waitcnt lgkmcnt(4)
    v_mfma_f32_32x32x16_bf16 v[56:71], v[48:51], v[112:115], v[56:71]
    v_mfma_f32_32x32x16_bf16 v[72:87], v[52:55], v[112:115], v[72:87]
    s_lshl_b32 s45, s46, 14
    s_add_u32 m0, s47, 20608
    s_add_u32 s45, s45, s50
    buffer_load_dwordx4 v3, s[16:19], s45 offen sc1 lds
    ds_read_b128 v[48:51], v22 offset:4096
    ds_read_b128 v[52:55], v22 offset:5120
    s_waitcnt lgkmcnt(4)
    v_mfma_f32_32x32x16_bf16 v[56:71], v[248:251], v[116:119], v[56:71]
    v_mfma_f32_32x32x16_bf16 v[72:87], v[252:255], v[116:119], v[72:87]
    s_add_u32 m0, s47, 21632
    s_add_u32 s45, s45, 1024
    buffer_load_dwordx4 v3, s[16:19], s45 offen sc1 lds
    s_lshr_b64 s[98:99], s[98:99], 4
    s_and_b32 s46, s98, 15
    ds_read_b128 v[248:251], v22 offset:8192
    ds_read_b128 v[252:255], v22 offset:9216
    s_waitcnt lgkmcnt(4)
    v_mfma_f32_32x32x16_bf16 v[56:71], v[40:43], v[120:123], v[56:71]
    v_mfma_f32_32x32x16_bf16 v[72:87], v[44:47], v[120:123], v[72:87]
    s_cmp_eq_u64 s[74:75], 0
    s_cbranch_scc1 L_sp_2
    s_mov_b64 exec, s[74:75]
    v_mov_b64 v[0:1], v[18:19]
    v_mov_b32_dpp v18, v16 row_half_mirror row_mask:0xf bank_mask:0x5
    v_mov_b32_dpp v19, v17 row_half_mirror row_mask:0xf bank_mask:0x5
    v_mov_b32_dpp v16, v0 row_half_mirror row_mask:0xf bank_mask:0xa
    v_mov_b32_dpp v17, v1 row_half_mirror row_mask:0xf bank_mask:0xa
    s_mov_b64 exec, -1
L_sp_2:
    buffer_store_dwordx4 v[16:19], v26, s[16:19], 0 offen sc1
    ds_read_b128 v[40:43], v22 offset:12288
    ds_read_b128 v[44:47], v22 offset:13312
    s_waitcnt lgkmcnt(4)
    v_mfma_f32_32x32x16_bf16 v[56:71], v[48:51], v[124:127], v[56:71]
    v_mfma_f32_32x32x16_bf16 v[72:87], v[52:55], v[124:127], v[72:87]
    s_lshl_b32 s45, s46, 14
    s_add_u32 m0, s47, 36992
    s_add_u32 s45, s45, s50
    buffer_load_dwordx4 v3, s[16:19], s45 offen sc1 lds
    ds_read_b128 v[48:51], v22 offset:16896
    ds_read_b128 v[52:55], v22 offset:17920
    s_waitcnt lgkmcnt(4)
    v_mfma_f32_32x32x16_bf16 v[56:71], v[248:251], v[128:131], v[56:71]
    v_mfma_f32_32x32x16_bf16 v[72:87], v[252:255], v[128:131], v[72:87]
    s_add_u32 m0, s47, 38016
    s_add_u32 s45, s45, 1024
    buffer_load_dwordx4 v3, s[16:19], s45 offen sc1 lds
    s_lshr_b64 s[98:99], s[98:99], 4
    s_and_b32 s46, s98, 15
    ds_read_b128 v[248:251], v22 offset:20992
    ds_read_b128 v[252:255], v22 offset:22016
    s_waitcnt lgkmcnt(4)
    v_mfma_f32_32x32x16_bf16 v[56:71], v[40:43], v[132:135], v[56:71]
    v_mfma_f32_32x32x16_bf16 v[72:87], v[44:47], v[132:135], v[72:87]
    s_cmp_eq_u64 s[76:77], 0
    s_cbranch_scc1 L_sp_3
    s_mov_b64 exec, s[76:77]
    v_mov_b64 v[0:1], v[34:35]
    v_mov_b32_dpp v34, v32 row_half_mirror row_mask:0xf bank_mask:0x5
    v_mov_b32_dpp v35, v33 row_half_mirror row_mask:0xf bank_mask:0x5
    v_mov_b32_dpp v32, v0 row_half_mirror row_mask:0xf bank_mask:0xa
    v_mov_b32_dpp v33, v1 row_half_mirror row_mask:0xf bank_mask:0xa
    s_mov_b64 exec, -1
L_sp_3:
    buffer_store_dwordx4 v[32:35], v27, s[16:19], 0 offen sc1
    ds_read_b128 v[40:43], v22 offset:25088
    ds_read_b128 v[44:47], v22 offset:26112
    s_waitcnt lgkmcnt(4)
    v_mfma_f32_32x32x16_bf16 v[56:71], v[48:51], v[136:139], v[56:71]
    v_mfma_f32_32x32x16_bf16 v[72:87], v[52:55], v[136:139], v[72:87]
    ds_read_b128 v[48:51], v22 offset:29184
    ds_read_b128 v[52:55], v22 offset:30208
    s_waitcnt lgkmcnt(4)
    v_mfma_f32_32x32x16_bf16 v[56:71], v[248:251], v[140:143], v[56:71]
    v_mfma_f32_32x32x16_bf16 v[72:87], v[252:255], v[140:143], v[72:87]
    ds_read_b128 v[248:251], v22 offset:33280
    ds_read_b128 v[252:255], v22 offset:34304
    s_waitcnt lgkmcnt(4)
    v_mfma_f32_32x32x16_bf16 v[56:71], v[40:43], v[144:147], v[56:71]
    s_lshr_b32 s54, s37, 3
    s_lshl_b32 s66, s36, 2
    s_add_u32 s66, s66, s54
    s_and_b32 s54, s37, 7
    v_mfma_f32_32x32x16_bf16 v[72:87], v[44:47], v[144:147], v[72:87]
    s_lshl_b32 s54, s54, 3
    s_lshl_b32 s67, s41, 1
    s_add_u32 s67, s67, s54
    s_mul_i32 s71, s66, 163840
    ds_read_b128 v[40:43], v22 offset:37376
    ds_read_b128 v[44:47], v22 offset:38400
    s_waitcnt lgkmcnt(4)
    v_mfma_f32_32x32x16_bf16 v[56:71], v[48:51], v[148:151], v[56:71]
    s_add_u32 s71, s71, 2621440
    s_mul_i32 s54, s41, 5120
    s_mul_i32 s70, s42, 61440
    s_add_u32 s70, s70, s54
    v_mfma_f32_32x32x16_bf16 v[72:87], v[52:55], v[148:151], v[72:87]
    s_mov_b32 s4, 0xfffff
    s_mov_b32 s5, 0xfffff
    s_mov_b32 s68, 0
    v_mov_b32 v39, 163832
    ds_read_b128 v[48:51], v22 offset:41472
    ds_read_b128 v[52:55], v22 offset:42496
    s_waitcnt lgkmcnt(4)
    v_mfma_f32_32x32x16_bf16 v[56:71], v[248:251], v[152:155], v[56:71]
    v_mov_b32 v36, 0
    ds_write_b32 v39, v36
    s_min_u32 s72, s38, 1
    s_xor_b32 s72, s72, 1
    v_mfma_f32_32x32x16_bf16 v[72:87], v[252:255], v[152:155], v[72:87]
    s_mov_b32 s63, 1
    s_mul_i32 s54, s66, 20
    s_lshr_b32 s55, s54, 7
    s_add_u32 s54, s54, 19
    ds_read_b128 v[248:251], v22 offset:45568
    ds_read_b128 v[252:255], v22 offset:46592
    s_waitcnt lgkmcnt(4)
    v_mfma_f32_32x32x16_bf16 v[56:71], v[40:43], v[156:159], v[56:71]
    s_lshr_b32 s54, s54, 7
    s_sub_u32 s54, s54, s55
    s_lshl_b32 s54, s54, 8
    s_lshl_b32 s78, s55, 8
    v_mfma_f32_32x32x16_bf16 v[72:87], v[44:47], v[156:159], v[72:87]
    s_add_u32 s78, s78, 10706944
    v_min_u32 v6, 47, v2
    v_lshrrev_b32 v38, 4, v6
    v_mul_u32_u24 v38, 1280, v38
    ds_read_b128 v[40:43], v20 offset:0
    ds_read_b128 v[44:47], v20 offset:1024
    s_waitcnt lgkmcnt(4)
    v_mfma_f32_32x32x16_bf16 v[56:71], v[48:51], v[160:163], v[56:71]
    v_bfe_u32 v7, v6, 3, 1
    v_mul_u32_u24 v7, s54, v7
    v_and_b32 v6, 7, v6
    v_lshlrev_b32 v6, 4, v6
    v_mfma_f32_32x32x16_bf16 v[72:87], v[52:55], v[160:163], v[72:87]
    v_add3_u32 v38, v38, v7, v6
    ds_read_b128 v[48:51], v20 offset:4096
    ds_read_b128 v[52:55], v20 offset:5120
    s_waitcnt lgkmcnt(4)
    v_mfma_f32_32x32x16_bf16 v[56:71], v[248:251], v[164:167], v[56:71]
    v_mfma_f32_32x32x16_bf16 v[72:87], v[252:255], v[164:167], v[72:87]
    ds_read_b128 v[248:251], v20 offset:8192
    ds_read_b128 v[252:255], v20 offset:9216
    s_waitcnt lgkmcnt(4)
    v_mfma_f32_32x32x16_bf16 v[56:71], v[40:43], v[168:171], v[56:71]
    v_and_b32 v15, 0x13, v4
    v_bfe_u32 v6, v4, 2, 1
    v_lshl_or_b32 v15, v6, 3, v15
    v_mfma_f32_32x32x16_bf16 v[72:87], v[44:47], v[168:171], v[72:87]
    v_bfe_u32 v6, v4, 3, 1
    v_lshl_or_b32 v15, v6, 2, v15
    v_bfe_u32 v6, v4, 2, 1
    ds_read_b128 v[40:43], v20 offset:12288
    ds_read_b128 v[44:47], v20 offset:13312
    s_waitcnt lgkmcnt(4)
    v_mfma_f32_32x32x16_bf16 v[56:71], v[48:51], v[172:175], v[56:71]
    v_mul_u32_u24 v6, 7, v6
    v_lshlrev_b32 v7, 1, v4
    v_and_b32 v7, 6, v7
    v_mfma_f32_32x32x16_bf16 v[72:87], v[52:55], v[172:175], v[72:87]
    v_xor_b32 v6, v6, v7
    v_and_b32 v7, 24, v4
    v_add_u32 v6, v6, v7
    s_waitcnt vmcnt(0)
    s_barrier
    ds_read_b128 v[48:51], v20 offset:20608
    ds_read_b128 v[52:55], v20 offset:21632
    s_cmp_lg_u32 s38, 7
    s_cbranch_scc1 L_qa_42
    s_lshl_b32 s60, s40, 4
    s_add_u32 s60, s60, s39
    s_lshl_b32 s60, s60, 4
    s_add_u32 s60, s60, 10706944
    v_mov_b32 v0, 0
    v_mov_b32 v1, s43
    s_mov_b64 exec, 1
    buffer_store_dword v1, v0, s[16:19], s60 offen sc0 sc1
    s_mov_b64 exec, -1
L_qa_42:
    s_waitcnt lgkmcnt(4)
    v_mfma_f32_32x32x16_bf16 v[56:71], v[248:251], v[176:179], v[56:71]
    v_lshlrev_b32 v6, 3, v6
    v_lshl_add_u32 v12, v5, 2, v6
    v_bfe_u32 v6, v15, 2, 1
    v_mfma_f32_32x32x16_bf16 v[72:87], v[252:255], v[176:179], v[72:87]
    v_mul_u32_u24 v6, 7, v6
    v_lshlrev_b32 v7, 1, v15
    v_and_b32 v7, 6, v7
    s_lshl_b32 s45, s46, 14
    s_add_u32 m0, s47, 82432
    s_add_u32 s45, s45, s50
    buffer_load_dwordx4 v3, s[16:19], s45 offen sc1 lds
    s_add_u32 m0, s47, 83456
    s_add_u32 s45, s45, 1024
    buffer_load_dwordx4 v3, s[16:19], s45 offen sc1 lds
    s_lshr_b64 s[98:99], s[98:99], 4
    s_and_b32 s46, s98, 15
    ds_read_b128 v[248:251], v20 offset:24704
    ds_read_b128 v[252:255], v20 offset:25728
    s_waitcnt lgkmcnt(4)
    v_mfma_f32_32x32x16_bf16 v[56:71], v[40:43], v[180:183], v[56:71]
    v_xor_b32 v6, v6, v7
    v_and_b32 v7, 24, v15
    v_add_u32 v6, v6, v7
    v_mfma_f32_32x32x16_bf16 v[72:87], v[44:47], v[180:183], v[72:87]
    v_lshlrev_b32 v6, 3, v6
    v_lshl_add_u32 v165, v5, 2, v6
    v_lshlrev_b32 v164, 4, v15
    s_lshl_b32 s45, s46, 14
    s_add_u32 m0, s47, 98816
    s_add_u32 s45, s45, s50
    buffer_load_dwordx4 v3, s[16:19], s45 offen sc1 lds
    s_add_u32 m0, s47, 99840
    s_add_u32 s45, s45, 1024
    buffer_load_dwordx4 v3, s[16:19], s45 offen sc1 lds
    s_lshr_b64 s[98:99], s[98:99], 4
    s_and_b32 s46, s98, 15
    ds_read_b128 v[40:43], v20 offset:28800
    ds_read_b128 v[44:47], v20 offset:29824
    s_waitcnt lgkmcnt(4)
    v_mfma_f32_32x32x16_bf16 v[56:71], v[48:51], v[184:187], v[56:71]
    v_lshl_add_u32 v164, v5, 9, v164
    s_mul_i32 s54, s41, 5120
    v_add_u32 v163, s54, v3
    v_mfma_f32_32x32x16_bf16 v[72:87], v[52:55], v[184:187], v[72:87]
    v_cmp_gt_u32 vcc, 20, v4
    v_and_b32 v6, 27, v4
    v_mov_b32 v7, 31
    ds_read_b128 v[48:51], v20 offset:32896
    ds_read_b128 v[52:55], v20 offset:33920
    s_waitcnt lgkmcnt(4)
    v_mfma_f32_32x32x16_bf16 v[56:71], v[248:251], v[188:191], v[56:71]
    v_cndmask_b32 v15, v7, v15, vcc
    v_cmp_eq_u32 vcc, 24, v6
    v_bfe_u32 v6, v2, 4, 1
    v_mfma_f32_32x32x16_bf16 v[72:87], v[252:255], v[188:191], v[72:87]
    v_mul_u32_u24 v6, 20480, v6
    v_cndmask_b32 v15, v15, 20, vcc
    v_and_b32 v7, 15, v2
    ds_read_b128 v[248:251], v20 offset:36992
    ds_read_b128 v[252:255], v20 offset:38016
    s_waitcnt lgkmcnt(4)
    v_mfma_f32_32x32x16_bf16 v[56:71], v[40:43], v[192:195], v[56:71]
    v_lshl_add_u32 v13, v7, 4, v6
    v_lshl_add_u32 v13, v5, 8, v13
    v_lshl_add_u32 v6, v7, 3, v6
    v_mfma_f32_32x32x16_bf16 v[72:87], v[44:47], v[192:195], v[72:87]
    v_add_u32 v6, 16384, v6
    v_cmp_gt_u32 vcc, 32, v2
    v_mov_b32 v7, 2147483632
    ds_read_b128 v[40:43], v20 offset:41088
    ds_read_b128 v[44:47], v20 offset:42112
    s_waitcnt lgkmcnt(4)
    v_mfma_f32_32x32x16_bf16 v[56:71], v[48:51], v[196:199], v[56:71]
    v_mov_b32 v162, 0xdddddddd
    v_cndmask_b32 v14, v7, v6, vcc
    s_mul_i32 s55, s42, 61440
    v_mfma_f32_32x32x16_bf16 v[72:87], v[52:55], v[196:199], v[72:87]
    v_add_u32 v160, s55, v164
    v_add_u32 v161, s55, v165
    v_mul_u32_u24 v7, 320, v5
    ds_read_b128 v[48:51], v20 offset:45184
    ds_read_b128 v[52:55], v20 offset:46208
    s_waitcnt lgkmcnt(4)
    v_mfma_f32_32x32x16_bf16 v[56:71], v[248:251], v[200:203], v[56:71]
    v_lshl_add_u32 v7, v15, 4, v7
    v_cmp_eq_u32 vcc, 20, v15
    v_mov_b32 v8, 0x3f803f80
    v_mfma_f32_32x32x16_bf16 v[72:87], v[252:255], v[200:203], v[72:87]
    v_add_u32 v152, s55, v7
    v_cndmask_b32 v136, 0, v8, vcc
    v_cndmask_b32 v137, 0, v8, vcc
    ds_read_b128 v[248:251], v20 offset:49280
    ds_read_b128 v[252:255], v20 offset:50304
    s_waitcnt lgkmcnt(4)
    v_mfma_f32_32x32x16_bf16 v[56:71], v[40:43], v[204:207], v[56:71]
    v_mov_b64 v[156:157], 0
    v_mov_b64 v[158:159], 0
    v_mov_b64 v[138:139], v[136:137]
    v_mfma_f32_32x32x16_bf16 v[72:87], v[44:47], v[204:207], v[72:87]
    v_mov_b64 v[140:141], v[136:137]
    v_mov_b64 v[142:143], v[136:137]
    v_mov_b64 v[144:145], v[136:137]
    s_waitcnt vmcnt(0)
    s_barrier
    ds_read_b128 v[40:43], v22 offset:16896
    ds_read_b128 v[44:47], v22 offset:17920
    s_waitcnt lgkmcnt(4)
    v_mfma_f32_32x32x16_bf16 v[56:71], v[48:51], v[208:211], v[56:71]
    v_mov_b64 v[146:147], v[136:137]
    v_mov_b64 v[148:149], v[136:137]
    v_mov_b64 v[150:151], v[136:137]
    v_mfma_f32_32x32x16_bf16 v[72:87], v[52:55], v[208:211], v[72:87]
    v_mov_b32 v133, 0x3f803f80
    v_mov_b32 v135, 0x3f803f80
    v_mov_b32 v121, 0
    s_cmp_eq_u32 s72, 0
    s_cbranch_scc1 L_pk_u1
    buffer_load_dword v36, v38, s[16:19], s78 offen sc0 sc1
    buffer_load_dword v37, v38, s[16:19], s78 offen offset:128 sc0 sc1
L_pk_u1:
    ds_read_b128 v[48:51], v22 offset:20992
    ds_read_b128 v[52:55], v22 offset:22016
    s_waitcnt lgkmcnt(4)
    v_mfma_f32_32x32x16_bf16 v[56:71], v[248:251], v[212:215], v[56:71]
    v_mov_b32 v123, 0
    v_mov_b32 v166, 0xff800000
    v_mov_b32 v167, 0xff800000
    v_mfma_f32_32x32x16_bf16 v[72:87], v[252:255], v[212:215], v[72:87]
    ds_read_b128 v[248:251], v22 offset:25088
    ds_read_b128 v[252:255], v22 offset:26112
    s_waitcnt lgkmcnt(4)
    v_mfma_f32_32x32x16_bf16 v[56:71], v[40:43], v[216:219], v[56:71]
    v_mfma_f32_32x32x16_bf16 v[72:87], v[44:47], v[216:219], v[72:87]
    ds_read_b128 v[40:43], v22 offset:29184
    ds_read_b128 v[44:47], v22 offset:30208
    s_waitcnt lgkmcnt(4)
    v_mfma_f32_32x32x16_bf16 v[56:71], v[48:51], v[220:223], v[56:71]
    s_lshl_b32 s54, s41, 5
    v_add_u32 v194, s54, v4
    v_mul_u32_u24 v194, 272, v194
    v_mfma_f32_32x32x16_bf16 v[72:87], v[52:55], v[220:223], v[72:87]
    v_add_u32 v194, 126976, v194
    v_mul_u32_u24 v196, 48, v5
    v_add_u32 v196, v196, v194
    ds_read_b128 v[48:51], v22 offset:33280
    ds_read_b128 v[52:55], v22 offset:34304
    s_waitcnt lgkmcnt(4)
    v_mfma_f32_32x32x16_bf16 v[56:71], v[248:251], v[224:227], v[56:71]
    v_mul_u32_u24 v195, 80, v5
    v_add_u32 v195, v195, v194
    s_and_b32 s57, s38, 1
    v_mfma_f32_32x32x16_bf16 v[72:87], v[252:255], v[224:227], v[72:87]
    s_bfe_u32 s58, s38, 0x10001
    v_bfe_u32 v6, v2, 2, 2
    v_lshl_add_u32 v6, v5, 3, v6
    ds_read_b128 v[248:251], v22 offset:37376
    ds_read_b128 v[252:255], v22 offset:38400
    s_waitcnt lgkmcnt(4)
    v_mfma_f32_32x32x16_bf16 v[56:71], v[40:43], v[228:231], v[56:71]
    v_mul_u32_u24 v6, 272, v6
    v_bfe_u32 v7, v2, 4, 1
    v_lshl_add_u32 v6, v7, 5, v6
    v_mfma_f32_32x32x16_bf16 v[72:87], v[44:47], v[228:231], v[72:87]
    v_and_b32 v7, 3, v2
    v_lshl_add_u32 v6, v7, 3, v6
    s_mul_i32 s54, s57, 48
    ds_read_b128 v[40:43], v22 offset:41472
    ds_read_b128 v[44:47], v22 offset:42496
    s_waitcnt lgkmcnt(4)
    v_mfma_f32_32x32x16_bf16 v[56:71], v[48:51], v[232:235], v[56:71]
    s_add_u32 s54, s54, 127136
    v_add_u32 v197, s54, v6
    s_mul_i32 s54, s57, 80
    v_mfma_f32_32x32x16_bf16 v[72:87], v[52:55], v[232:235], v[72:87]
    s_lshl_b32 s56, s58, 6
    s_add_u32 s54, s54, s56
    s_add_u32 s54, s54, 126976
    ds_read_b128 v[48:51], v22 offset:45568
    ds_read_b128 v[52:55], v22 offset:46592
    s_waitcnt lgkmcnt(4)
    v_mfma_f32_32x32x16_bf16 v[56:71], v[248:251], v[236:239], v[56:71]
    v_add_u32 v198, s54, v6
    s_lshl_b32 s79, s40, 1
    s_add_u32 s79, s79, s57
    v_mfma_f32_32x32x16_bf16 v[72:87], v[252:255], v[236:239], v[72:87]
    s_lshl_b32 s79, s79, 12
    s_add_u32 s79, s79, 10551296
    s_lshl_b32 s56, s58, 5
    s_waitcnt lgkmcnt(2)
    v_mfma_f32_32x32x16_bf16 v[56:71], v[40:43], v[240:243], v[56:71]
    v_add_u32 v6, s56, v4
    v_cmp_gt_u32 vcc, 40, v6
    v_lshlrev_b32 v6, 2, v6
    v_mfma_f32_32x32x16_bf16 v[72:87], v[44:47], v[240:243], v[72:87]
    v_mul_u32_u24 v7, 640, v5
    v_add_u32 v6, v6, v7
    v_mov_b32 v7, 2147483632
    s_cmp_eq_u32 s72, 0
    s_cbranch_scc1 L_pk_u2
    s_waitcnt vmcnt(0)
    v_xor_b32 v36, s43, v36
    v_xor_b32 v37, s43, v37
    v_or_b32 v36, v36, v37
    v_cmp_ne_u32 s[60:61], 0, v36
    v_mov_b32 v36, 1
    s_nop 3
    s_or_b32 s61, s60, s61
    s_cbranch_scc1 L_pk_u2
    ds_write_b32 v39, v36
    s_mov_b32 s72, 0
    s_waitcnt lgkmcnt(0)
L_pk_u2:
    s_waitcnt lgkmcnt(0)
    v_mfma_f32_32x32x16_bf16 v[56:71], v[48:51], v[244:247], v[56:71]
    v_cndmask_b32 v199, v7, v6, vcc
    v_cmp_gt_u32 vcc, 32, v2
    s_nop 1
    v_mfma_f32_32x32x16_bf16 v[72:87], v[52:55], v[244:247], v[72:87]
    v_cndmask_b32 v216, v7, v199, vcc
    s_cmp_lg_u32 s43, 0
    s_cbranch_scc1 L_ngd_44
    v_mov_b32 v0, 0
    s_mov_b32 s62, 0x200000
L_ng_43:
    buffer_load_dword v1, v0, s[20:23], 0 offen sc0 sc1
    s_waitcnt vmcnt(0)
    v_readfirstlane_b32 s43, v1
    s_cmp_lg_u32 s43, 0
    s_cbranch_scc1 L_ngd_44
    s_sleep 8
    s_sub_u32 s62, s62, 1
    s_cmp_lg_u32 s62, 0
    s_cbranch_scc1 L_ng_43
L_ngd_44:
    s_cmp_eq_u32 s72, 0
    s_cbranch_scc1 L_q_other
    v_mov_b32 v0, v38
    s_mov_b32 s62, 0x200000
L_fw_45:
    buffer_load_dword v36, v0, s[16:19], s78 offen sc0 sc1
    buffer_load_dword v37, v0, s[16:19], s78 offen offset:128 sc0 sc1
    s_waitcnt vmcnt(0)
    v_xor_b32 v36, s43, v36
    v_xor_b32 v37, s43, v37
    v_or_b32 v36, v36, v37
    v_cmp_ne_u32 vcc, 0, v36
    s_nop 3
    s_cmp_eq_u64 vcc, 0
    s_cbranch_scc1 L_fwd_46
    s_sleep 2
    s_sub_u32 s62, s62, 1
    s_cmp_lg_u32 s62, 0
    s_cbranch_scc1 L_fw_45
L_fwd_46:
    v_mov_b32 v36, 1
    ds_write_b32 v39, v36
L_q_other:
    ds_read_b32 v35, v39
    s_waitcnt lgkmcnt(0)
    v_readfirstlane_b32 s60, v35
    s_nop 1
    s_cmp_eq_u32 s60, 0
    s_cbranch_scc1 L_q_notyet
    s_mul_i32 s54, s67, 1280
    s_mul_i32 s55, s66, 81920
    s_add_u32 s54, s54, s55
    s_add_u32 s54, s54, 0
    buffer_load_dwordx4 v[112:115], v3, s[16:19], s54 offen sc1
    v_max3_f32 v188, v56, v57, v58
    v_min3_f32 v190, v56, v57, v58
    v_max3_f32 v188, v59, v60, v188
    v_min3_f32 v190, v59, v60, v190
    v_max3_f32 v188, v61, v62, v188
    buffer_load_dword v120, v12, s[16:19], s54 offen offset:1024 sc1
    v_min3_f32 v190, v61, v62, v190
    v_max3_f32 v188, v63, v64, v188
    v_min3_f32 v190, v63, v64, v190
    v_max3_f32 v188, v65, v66, v188
    v_min3_f32 v190, v65, v66, v190
    buffer_load_dwordx4 v[116:119], v3, s[16:19], s54 offen offset:1280 sc1
    v_max3_f32 v188, v67, v68, v188
    v_min3_f32 v190, v67, v68, v190
    v_max3_f32 v188, v69, v70, v188
    v_min3_f32 v190, v69, v70, v190
    v_max3_f32 v188, v71, v72, v188
    buffer_load_dword v122, v12, s[16:19], s54 offen offset:2304 sc1
    v_min3_f32 v190, v71, v72, v190
    v_max3_f32 v188, v73, v74, v188
    v_min3_f32 v190, v73, v74, v190
    v_max_f32 v188, v75, v188
    v_min_f32 v190, v75, v190
    s_mul_i32 s69, s42, 81920
    s_add_u32 s69, s69, s71
    buffer_load_dwordx4 v[124:127], v164, s[16:19], s71 offen sc1
    s_mov_b32 s58, 0x3fb8aa3b
    s_mov_b32 s59, s58
    v_mul_f32 v189, s58, v188
    v_mul_f32 v191, s58, v190
    v_mul_f32 v188, s58, v188
    buffer_load_dword v132, v165, s[16:19], s71 offen offset:1024 sc1
    v_mul_f32 v190, s58, v190
    v_pk_fma_f32 v[168:169], v[56:57], s[58:59], v[190:191] neg_lo:[1,0,0] neg_hi:[1,0,0]
    v_pk_fma_f32 v[56:57], v[56:57], s[58:59], v[188:189] neg_lo:[0,0,1] neg_hi:[0,0,1]
    v_pk_fma_f32 v[170:171], v[58:59], s[58:59], v[190:191] neg_lo:[1,0,0] neg_hi:[1,0,0]
    v_pk_fma_f32 v[58:59], v[58:59], s[58:59], v[188:189] neg_lo:[0,0,1] neg_hi:[0,0,1]
    buffer_load_dwordx4 v[128:131], v164, s[16:19], s69 offen sc1
    v_pk_fma_f32 v[172:173], v[60:61], s[58:59], v[190:191] neg_lo:[1,0,0] neg_hi:[1,0,0]
    v_pk_fma_f32 v[60:61], v[60:61], s[58:59], v[188:189] neg_lo:[0,0,1] neg_hi:[0,0,1]
    v_pk_fma_f32 v[174:175], v[62:63], s[58:59], v[190:191] neg_lo:[1,0,0] neg_hi:[1,0,0]
    v_pk_fma_f32 v[62:63], v[62:63], s[58:59], v[188:189] neg_lo:[0,0,1] neg_hi:[0,0,1]
    v_pk_fma_f32 v[176:177], v[64:65], s[58:59], v[190:191] neg_lo:[1,0,0] neg_hi:[1,0,0]
    buffer_load_dword v134, v165, s[16:19], s69 offen offset:1024 sc1
    v_pk_fma_f32 v[64:65], v[64:65], s[58:59], v[188:189] neg_lo:[0,0,1] neg_hi:[0,0,1]
    v_pk_fma_f32 v[178:179], v[66:67], s[58:59], v[190:191] neg_lo:[1,0,0] neg_hi:[1,0,0]
    v_pk_fma_f32 v[66:67], v[66:67], s[58:59], v[188:189] neg_lo:[0,0,1] neg_hi:[0,0,1]
    v_pk_fma_f32 v[180:181], v[68:69], s[58:59], v[190:191] neg_lo:[1,0,0] neg_hi:[1,0,0]
    v_pk_fma_f32 v[68:69], v[68:69], s[58:59], v[188:189] neg_lo:[0,0,1] neg_hi:[0,0,1]
    s_add_u32 s69, s69, 1280
    s_add_u32 m0, s70, 0
    s_add_u32 s54, s69, 4096
    buffer_load_dwordx4 v163, s[16:19], s69 offen sc1 lds
    v_pk_fma_f32 v[182:183], v[70:71], s[58:59], v[190:191] neg_lo:[1,0,0] neg_hi:[1,0,0]
    v_pk_fma_f32 v[70:71], v[70:71], s[58:59], v[188:189] neg_lo:[0,0,1] neg_hi:[0,0,1]
    v_pk_fma_f32 v[184:185], v[72:73], s[58:59], v[190:191] neg_lo:[1,0,0] neg_hi:[1,0,0]
    v_pk_fma_f32 v[72:73], v[72:73], s[58:59], v[188:189] neg_lo:[0,0,1] neg_hi:[0,0,1]
    v_pk_fma_f32 v[186:187], v[74:75], s[58:59], v[190:191] neg_lo:[1,0,0] neg_hi:[1,0,0]
    buffer_load_dwordx4 v163, s[16:19], s69 offen offset:1024 sc1 lds
    v_pk_fma_f32 v[74:75], v[74:75], s[58:59], v[188:189] neg_lo:[0,0,1] neg_hi:[0,0,1]
    v_exp_f32 v168, v168
    v_exp_f32 v56, v56
    v_exp_f32 v169, v169
    v_exp_f32 v57, v57
    buffer_load_dwordx4 v163, s[16:19], s69 offen offset:2048 sc1 lds
    v_exp_f32 v170, v170
    v_exp_f32 v58, v58
    v_exp_f32 v171, v171
    v_exp_f32 v59, v59
    v_exp_f32 v172, v172
    buffer_load_dwordx4 v163, s[16:19], s69 offen offset:3072 sc1 lds
    v_exp_f32 v60, v60
    v_exp_f32 v173, v173
    v_exp_f32 v61, v61
    v_exp_f32 v174, v174
    v_exp_f32 v62, v62
    s_add_u32 m0, s70, 4096
    s_add_u32 s69, s69, 20480
    buffer_load_dwordx4 v163, s[16:19], s54 offen sc1 lds
    v_exp_f32 v175, v175
    v_exp_f32 v63, v63
    v_exp_f32 v176, v176
    v_exp_f32 v64, v64
    v_exp_f32 v177, v177
    v_exp_f32 v65, v65
    v_exp_f32 v178, v178
    v_exp_f32 v66, v66
    v_exp_f32 v179, v179
    v_exp_f32 v67, v67
    v_exp_f32 v180, v180
    v_exp_f32 v68, v68
    v_exp_f32 v181, v181
    v_exp_f32 v69, v69
    v_exp_f32 v182, v182
    v_exp_f32 v70, v70
    v_exp_f32 v183, v183
    v_exp_f32 v71, v71
    v_exp_f32 v184, v184
    v_exp_f32 v72, v72
    v_exp_f32 v185, v185
    v_exp_f32 v73, v73
    v_exp_f32 v186, v186
    v_exp_f32 v74, v74
    v_exp_f32 v187, v187
    v_exp_f32 v75, v75
    v_pk_add_f32 v[190:191], v[56:57], v[58:59]
    v_pk_add_f32 v[192:193], v[168:169], v[170:171]
    v_pk_add_f32 v[190:191], v[190:191], v[60:61]
    v_pk_add_f32 v[192:193], v[192:193], v[172:173]
    v_pk_add_f32 v[190:191], v[190:191], v[62:63]
    v_pk_add_f32 v[192:193], v[192:193], v[174:175]
    v_pk_add_f32 v[190:191], v[190:191], v[64:65]
    v_pk_add_f32 v[192:193], v[192:193], v[176:177]
    v_pk_add_f32 v[190:191], v[190:191], v[66:67]
    v_pk_add_f32 v[192:193], v[192:193], v[178:179]
    v_pk_add_f32 v[190:191], v[190:191], v[68:69]
    v_pk_add_f32 v[192:193], v[192:193], v[180:181]
    v_pk_add_f32 v[190:191], v[190:191], v[70:71]
    v_pk_add_f32 v[192:193], v[192:193], v[182:183]
    v_pk_add_f32 v[190:191], v[190:191], v[72:73]
    v_pk_add_f32 v[192:193], v[192:193], v[184:185]
    v_pk_add_f32 v[190:191], v[190:191], v[74:75]
    v_pk_add_f32 v[192:193], v[192:193], v[186:187]
    v_add_f32 v190, v190, v191
    v_add_f32 v192, v192, v193
    v_rcp_f32 v190, v190
    v_rcp_f32 v192, v192
    v_mov_b32 v191, v190
    v_mov_b32 v193, v192
    v_pk_mul_f32 v[56:57], v[56:57], v[190:191]
    v_pk_mul_f32 v[168:169], v[168:169], v[192:193]
    v_pk_mul_f32 v[58:59], v[58:59], v[190:191]
    v_pk_mul_f32 v[170:171], v[170:171], v[192:193]
    v_pk_mul_f32 v[60:61], v[60:61], v[190:191]
    v_pk_mul_f32 v[172:173], v[172:173], v[192:193]
    v_pk_mul_f32 v[62:63], v[62:63], v[190:191]
    v_pk_mul_f32 v[174:175], v[174:175], v[192:193]
    v_pk_mul_f32 v[64:65], v[64:65], v[190:191]
    v_pk_mul_f32 v[176:177], v[176:177], v[192:193]
    v_pk_mul_f32 v[66:67], v[66:67], v[190:191]
    v_pk_mul_f32 v[178:179], v[178:179], v[192:193]
    v_pk_mul_f32 v[68:69], v[68:69], v[190:191]
    v_pk_mul_f32 v[180:181], v[180:181], v[192:193]
    v_pk_mul_f32 v[70:71], v[70:71], v[190:191]
    v_pk_mul_f32 v[182:183], v[182:183], v[192:193]
    v_pk_mul_f32 v[72:73], v[72:73], v[190:191]
    v_pk_mul_f32 v[184:185], v[184:185], v[192:193]
    v_pk_mul_f32 v[74:75], v[74:75], v[190:191]
    v_pk_mul_f32 v[186:187], v[186:187], v[192:193]
    v_cvt_pk_bf16_f32 v228, v56, v57
    v_cvt_pk_bf16_f32 v238, v168, v169
    v_cvt_pk_bf16_f32 v229, v58, v59
    v_cvt_pk_bf16_f32 v239, v170, v171
    v_cvt_pk_bf16_f32 v230, v60, v61
    v_cvt_pk_bf16_f32 v240, v172, v173
    v_cvt_pk_bf16_f32 v231, v62, v63
    v_cvt_pk_bf16_f32 v241, v174, v175
    v_cvt_pk_bf16_f32 v232, v64, v65
    v_cvt_pk_bf16_f32 v242, v176, v177
    v_cvt_pk_bf16_f32 v233, v66, v67
    v_cvt_pk_bf16_f32 v243, v178, v179
    v_cvt_pk_bf16_f32 v234, v68, v69
    v_cvt_pk_bf16_f32 v244, v180, v181
    v_cvt_pk_bf16_f32 v235, v70, v71
    v_cvt_pk_bf16_f32 v245, v182, v183
    v_cvt_pk_bf16_f32 v236, v72, v73
    v_cvt_pk_bf16_f32 v246, v184, v185
    v_cvt_pk_bf16_f32 v237, v74, v75
    v_cvt_pk_bf16_f32 v247, v186, v187
    s_branch L_q_done
L_q_notyet:
    v_max3_f32 v188, v56, v57, v58
    v_min3_f32 v190, v56, v57, v58
    v_max3_f32 v188, v59, v60, v188
    v_min3_f32 v190, v59, v60, v190
    v_max3_f32 v188, v61, v62, v188
    v_min3_f32 v190, v61, v62, v190
    v_max3_f32 v188, v63, v64, v188
    v_min3_f32 v190, v63, v64, v190
    v_max3_f32 v188, v65, v66, v188
    v_min3_f32 v190, v65, v66, v190
    v_max3_f32 v188, v67, v68, v188
    v_min3_f32 v190, v67, v68, v190
    v_max3_f32 v188, v69, v70, v188
    v_min3_f32 v190, v69, v70, v190
    v_max3_f32 v188, v71, v72, v188
    v_min3_f32 v190, v71, v72, v190
    v_max3_f32 v188, v73, v74, v188
    v_min3_f32 v190, v73, v74, v190
    v_max_f32 v188, v75, v188
    v_min_f32 v190, v75, v190
    s_mov_b32 s58, 0x3fb8aa3b
    s_mov_b32 s59, s58
    v_mul_f32 v189, s58, v188
    v_mul_f32 v191, s58, v190
    v_mul_f32 v188, s58, v188
    v_mul_f32 v190, s58, v190
    v_pk_fma_f32 v[168:169], v[56:57], s[58:59], v[190:191] neg_lo:[1,0,0] neg_hi:[1,0,0]
    v_pk_fma_f32 v[56:57], v[56:57], s[58:59], v[188:189] neg_lo:[0,0,1] neg_hi:[0,0,1]
    v_pk_fma_f32 v[170:171], v[58:59], s[58:59], v[190:191] neg_lo:[1,0,0] neg_hi:[1,0,0]
    v_pk_fma_f32 v[58:59], v[58:59], s[58:59], v[188:189] neg_lo:[0,0,1] neg_hi:[0,0,1]
    v_pk_fma_f32 v[172:173], v[60:61], s[58:59], v[190:191] neg_lo:[1,0,0] neg_hi:[1,0,0]
    v_pk_fma_f32 v[60:61], v[60:61], s[58:59], v[188:189] neg_lo:[0,0,1] neg_hi:[0,0,1]
    v_pk_fma_f32 v[174:175], v[62:63], s[58:59], v[190:191] neg_lo:[1,0,0] neg_hi:[1,0,0]
    v_pk_fma_f32 v[62:63], v[62:63], s[58:59], v[188:189] neg_lo:[0,0,1] neg_hi:[0,0,1]
    v_pk_fma_f32 v[176:177], v[64:65], s[58:59], v[190:191] neg_lo:[1,0,0] neg_hi:[1,0,0]
    v_pk_fma_f32 v[64:65], v[64:65], s[58:59], v[188:189] neg_lo:[0,0,1] neg_hi:[0,0,1]
    v_pk_fma_f32 v[178:179], v[66:67], s[58:59], v[190:191] neg_lo:[1,0,0] neg_hi:[1,0,0]
    v_pk_fma_f32 v[66:67], v[66:67], s[58:59], v[188:189] neg_lo:[0,0,1] neg_hi:[0,0,1]
    v_pk_fma_f32 v[180:181], v[68:69], s[58:59], v[190:191] neg_lo:[1,0,0] neg_hi:[1,0,0]
    v_pk_fma_f32 v[68:69], v[68:69], s[58:59], v[188:189] neg_lo:[0,0,1] neg_hi:[0,0,1]
    v_pk_fma_f32 v[182:183], v[70:71], s[58:59], v[190:191] neg_lo:[1,0,0] neg_hi:[1,0,0]
    v_pk_fma_f32 v[70:71], v[70:71], s[58:59], v[188:189] neg_lo:[0,0,1] neg_hi:[0,0,1]
    v_pk_fma_f32 v[184:185], v[72:73], s[58:59], v[190:191] neg_lo:[1,0,0] neg_hi:[1,0,0]
    v_pk_fma_f32 v[72:73], v[72:73], s[58:59], v[188:189] neg_lo:[0,0,1] neg_hi:[0,0,1]
    v_pk_fma_f32 v[186:187], v[74:75], s[58:59], v[190:191] neg_lo:[1,0,0] neg_hi:[1,0,0]
    v_pk_fma_f32 v[74:75], v[74:75], s[58:59], v[188:189] neg_lo:[0,0,1] neg_hi:[0,0,1]
    v_exp_f32 v168, v168
    v_exp_f32 v56, v56
    v_exp_f32 v169, v169
    v_exp_f32 v57, v57
    v_exp_f32 v170, v170
    v_exp_f32 v58, v58
    v_exp_f32 v171, v171
    v_exp_f32 v59, v59
    v_exp_f32 v172, v172
    v_exp_f32 v60, v60
    v_exp_f32 v173, v173
    v_exp_f32 v61, v61
    v_exp_f32 v174, v174
    v_exp_f32 v62, v62
    v_exp_f32 v175, v175
    v_exp_f32 v63, v63
    v_exp_f32 v176, v176
    v_exp_f32 v64, v64
    v_exp_f32 v177, v177
    v_exp_f32 v65, v65
    v_exp_f32 v178, v178
    v_exp_f32 v66, v66
    v_exp_f32 v179, v179
    v_exp_f32 v67, v67
    v_exp_f32 v180, v180
    v_exp_f32 v68, v68
    v_exp_f32 v181, v181
    v_exp_f32 v69, v69
    v_exp_f32 v182, v182
    v_exp_f32 v70, v70
    v_exp_f32 v183, v183
    v_exp_f32 v71, v71
    v_exp_f32 v184, v184
    v_exp_f32 v72, v72
    v_exp_f32 v185, v185
    v_exp_f32 v73, v73
    v_exp_f32 v186, v186
    v_exp_f32 v74, v74
    v_exp_f32 v187, v187
    v_exp_f32 v75, v75
    v_pk_add_f32 v[190:191], v[56:57], v[58:59]
    v_pk_add_f32 v[192:193], v[168:169], v[170:171]
    v_pk_add_f32 v[190:191], v[190:191], v[60:61]
    v_pk_add_f32 v[192:193], v[192:193], v[172:173]
    v_pk_add_f32 v[190:191], v[190:191], v[62:63]
    v_pk_add_f32 v[192:193], v[192:193], v[174:175]
    v_pk_add_f32 v[190:191], v[190:191], v[64:65]
    v_pk_add_f32 v[192:193], v[192:193], v[176:177]
    v_pk_add_f32 v[190:191], v[190:191], v[66:67]
    v_pk_add_f32 v[192:193], v[192:193], v[178:179]
    v_pk_add_f32 v[190:191], v[190:191], v[68:69]
    v_pk_add_f32 v[192:193], v[192:193], v[180:181]
    v_pk_add_f32 v[190:191], v[190:191], v[70:71]
    v_pk_add_f32 v[192:193], v[192:193], v[182:183]
    v_pk_add_f32 v[190:191], v[190:191], v[72:73]
    v_pk_add_f32 v[192:193], v[192:193], v[184:185]
    v_pk_add_f32 v[190:191], v[190:191], v[74:75]
    v_pk_add_f32 v[192:193], v[192:193], v[186:187]
    v_add_f32 v190, v190, v191
    v_add_f32 v192, v192, v193
    v_rcp_f32 v190, v190
    v_rcp_f32 v192, v192
    v_mov_b32 v191, v190
    v_mov_b32 v193, v192
    v_pk_mul_f32 v[56:57], v[56:57], v[190:191]
    v_pk_mul_f32 v[168:169], v[168:169], v[192:193]
    v_pk_mul_f32 v[58:59], v[58:59], v[190:191]
    v_pk_mul_f32 v[170:171], v[170:171], v[192:193]
    v_pk_mul_f32 v[60:61], v[60:61], v[190:191]
    v_pk_mul_f32 v[172:173], v[172:173], v[192:193]
    v_pk_mul_f32 v[62:63], v[62:63], v[190:191]
    v_pk_mul_f32 v[174:175], v[174:175], v[192:193]
    v_pk_mul_f32 v[64:65], v[64:65], v[190:191]
    v_pk_mul_f32 v[176:177], v[176:177], v[192:193]
    v_pk_mul_f32 v[66:67], v[66:67], v[190:191]
    v_pk_mul_f32 v[178:179], v[178:179], v[192:193]
    v_pk_mul_f32 v[68:69], v[68:69], v[190:191]
    v_pk_mul_f32 v[180:181], v[180:181], v[192:193]
    v_pk_mul_f32 v[70:71], v[70:71], v[190:191]
    v_pk_mul_f32 v[182:183], v[182:183], v[192:193]
    v_pk_mul_f32 v[72:73], v[72:73], v[190:191]
    v_pk_mul_f32 v[184:185], v[184:185], v[192:193]
    v_pk_mul_f32 v[74:75], v[74:75], v[190:191]
    v_pk_mul_f32 v[186:187], v[186:187], v[192:193]
    v_cvt_pk_bf16_f32 v228, v56, v57
    v_cvt_pk_bf16_f32 v238, v168, v169
    v_cvt_pk_bf16_f32 v229, v58, v59
    v_cvt_pk_bf16_f32 v239, v170, v171
    v_cvt_pk_bf16_f32 v230, v60, v61
    v_cvt_pk_bf16_f32 v240, v172, v173
    v_cvt_pk_bf16_f32 v231, v62, v63
    v_cvt_pk_bf16_f32 v241, v174, v175
    v_cvt_pk_bf16_f32 v232, v64, v65
    v_cvt_pk_bf16_f32 v242, v176, v177
    v_cvt_pk_bf16_f32 v233, v66, v67
    v_cvt_pk_bf16_f32 v243, v178, v179
    v_cvt_pk_bf16_f32 v234, v68, v69
    v_cvt_pk_bf16_f32 v244, v180, v181
    v_cvt_pk_bf16_f32 v235, v70, v71
    v_cvt_pk_bf16_f32 v245, v182, v183
    v_cvt_pk_bf16_f32 v236, v72, v73
    v_cvt_pk_bf16_f32 v246, v184, v185
    v_cvt_pk_bf16_f32 v237, v74, v75
    v_cvt_pk_bf16_f32 v247, v186, v187
    s_mov_b32 s62, 0x4000000
L_q_spin:
    ds_read_b32 v35, v39
    s_waitcnt lgkmcnt(0)
    v_readfirstlane_b32 s60, v35
    s_cmp_lg_u32 s60, 0
    s_cbranch_scc1 L_q_go
    s_sleep 1
    s_sub_u32 s62, s62, 1
    s_cmp_lg_u32 s62, 0
    s_cbranch_scc1 L_q_spin
L_q_go:
    s_mul_i32 s54, s67, 1280
    s_mul_i32 s55, s66, 81920
    s_add_u32 s54, s54, s55
    s_add_u32 s54, s54, 0
    buffer_load_dwordx4 v[112:115], v3, s[16:19], s54 offen sc1
    buffer_load_dword v120, v12, s[16:19], s54 offen offset:1024 sc1
    buffer_load_dwordx4 v[116:119], v3, s[16:19], s54 offen offset:1280 sc1
    buffer_load_dword v122, v12, s[16:19], s54 offen offset:2304 sc1
    s_mul_i32 s69, s42, 81920
    s_add_u32 s69, s69, s71
    buffer_load_dwordx4 v[124:127], v164, s[16:19], s71 offen sc1
    buffer_load_dword v132, v165, s[16:19], s71 offen offset:1024 sc1
    buffer_load_dwordx4 v[128:131], v164, s[16:19], s69 offen sc1
    buffer_load_dword v134, v165, s[16:19], s69 offen offset:1024 sc1
    s_add_u32 s69, s69, 1280
    s_add_u32 m0, s70, 0
    s_add_u32 s54, s69, 4096
    buffer_load_dwordx4 v163, s[16:19], s69 offen sc1 lds
    buffer_load_dwordx4 v163, s[16:19], s69 offen offset:1024 sc1 lds
    buffer_load_dwordx4 v163, s[16:19], s69 offen offset:2048 sc1 lds
    buffer_load_dwordx4 v163, s[16:19], s69 offen offset:3072 sc1 lds
    s_add_u32 m0, s70, 4096
    s_add_u32 s69, s69, 20480
    buffer_load_dwordx4 v163, s[16:19], s54 offen sc1 lds
L_q_done:
    s_lshl_b32 s54, s41, 9
    s_add_u32 s54, s54, 122880
    v_lshl_add_u32 v6, v2, 2, s54
    s_cmp_lg_u32 s42, 0
    s_cbranch_scc1 L_c_47
    s_waitcnt vmcnt(5)
    v_mfma_f32_32x32x16_bf16 v[16:31], v[124:127], v[112:115], 0
    v_mfma_f32_32x32x8_bf16 v[16:31], v[132:133], v[120:121], v[16:31]
    v_mfma_f32_32x32x16_bf16 v[32:47], v[124:127], v[116:119], 0
    v_mfma_f32_32x32x8_bf16 v[32:47], v[132:133], v[122:123], v[32:47]
L_c_47:
    v_cvt_pk_bf16_f32 v168, v76, v77
    v_cvt_pk_bf16_f32 v169, v78, v79
    v_cvt_pk_bf16_f32 v170, v80, v81
    v_cvt_pk_bf16_f32 v171, v82, v83
    v_cvt_pk_bf16_f32 v172, v84, v85
    v_cvt_pk_bf16_f32 v173, v86, v87
    s_cmp_eq_u32 s42, 0
    s_cbranch_scc0 L_b_k
    ds_write_b128 v196, v[168:171] offset:160
    ds_write_b64 v196, v[172:173] offset:176
    v_mov_b64 v[248:249], 0
    v_mov_b64 v[250:251], 0
    v_permlane32_swap_b32 v228, v232
    v_permlane32_swap_b32 v229, v233
    v_permlane32_swap_b32 v230, v234
    v_permlane32_swap_b32 v231, v235
    v_permlane32_swap_b32 v236, v240
    v_permlane32_swap_b32 v237, v241
    v_permlane32_swap_b32 v238, v242
    v_permlane32_swap_b32 v239, v243
    v_permlane32_swap_b32 v244, v248
    v_permlane32_swap_b32 v245, v249
    v_permlane32_swap_b32 v246, v250
    v_permlane32_swap_b32 v247, v251
    s_branch L_b_staged
L_b_k:
    v_mul_f32 v84, 0xbfb8aa3b, v84
    v_exp_f32 v84, v84
    v_mov_b32 v172, 0x3f80
    v_add_f32 v84, 1.0, v84
    v_rcp_f32 v174, v84
    v_mov_b32 v173, 0
    ds_write_b64 v196, v[168:169] offset:184
    ds_write_b128 v196, v[170:173] offset:192
    v_sub_f32 v175, 1.0, v174
    ds_write_b128 v195, v[228:231] offset:0
    ds_write_b128 v195, v[232:235] offset:16
    ds_write_b128 v195, v[236:239] offset:32
    ds_write_b128 v195, v[240:243] offset:48
    ds_write_b128 v195, v[244:247] offset:64
    ds_write_b32 v194, v175 offset:256
    s_cmp_lg_u32 s40, 0
    s_cbranch_scc1 L_b_staged
    s_lshl_b32 s54, s48, 7
    s_add_u32 s54, s54, 10682368
    v_lshlrev_b32 v0, 2, v4
    buffer_store_dword v174, v0, s[16:19], s54 offen sc1
L_b_staged:
    v_mfma_f32_32x32x16_bf16 v[80:95], v[156:159], v[156:159], 0
    v_mfma_f32_32x32x16_bf16 v[96:111], v[156:159], v[156:159], 0
    s_cmp_lg_u32 s42, 0
    s_cbranch_scc1 L_c_48
    v_max3_f32 v166, v16, v17, v166
    v_max3_f32 v167, v32, v33, v167
    v_max3_f32 v166, v18, v19, v166
    v_max3_f32 v167, v34, v35, v167
    v_max3_f32 v166, v20, v21, v166
    v_max3_f32 v167, v36, v37, v167
    v_max3_f32 v166, v22, v23, v166
    v_max3_f32 v167, v38, v39, v167
    v_max3_f32 v166, v24, v25, v166
    v_max3_f32 v167, v40, v41, v167
    v_max3_f32 v166, v26, v27, v166
    v_max3_f32 v167, v42, v43, v167
    v_max3_f32 v166, v28, v29, v166
    v_max3_f32 v167, v44, v45, v167
    v_max3_f32 v166, v30, v31, v166
    v_max3_f32 v167, v46, v47, v167
    v_cmp_gt_u32 vcc, 32, v2
    v_mov_b32 v176, v166
    v_mov_b32 v179, v167
    s_nop 0
    v_permlane32_swap_b32 v176, v166
    v_permlane32_swap_b32 v179, v167
    s_nop 0
    v_max_f32 v176, v176, v166
    v_max_f32 v179, v179, v167
    v_xor_b32 v176, 0x80000000, v176
    v_xor_b32 v179, 0x80000000, v179
    v_and_b32 v177, 0xffff0000, v176
    v_and_b32 v180, 0xffff0000, v179
    v_sub_f32 v176, v176, v177
    v_sub_f32 v179, v179, v180
    v_and_b32 v178, 0xffff0000, v176
    v_and_b32 v181, 0xffff0000, v179
    v_sub_f32 v176, v176, v178
    v_sub_f32 v179, v179, v181
    v_lshrrev_b32 v177, 16, v177
    v_lshrrev_b32 v180, 16, v180
    v_or_b32 v177, v177, v178
    v_or_b32 v180, v180, v181
    v_lshrrev_b32 v176, 16, v176
    v_lshrrev_b32 v179, 16, v179
    v_cndmask_b32 v121, v176, v177, vcc
    v_cndmask_b32 v123, v179, v180, vcc
    s_nop 1
    ds_write_b32 v6, v121
    ds_write_b32 v6, v123 offset:256
    v_mfma_f32_32x32x16_bf16 v[16:31], v[128:131], v[112:115], 0
    v_mfma_f32_32x32x8_bf16 v[16:31], v[134:135], v[120:121], v[16:31]
    v_mfma_f32_32x32x16_bf16 v[32:47], v[128:131], v[116:119], 0
    v_mfma_f32_32x32x8_bf16 v[32:47], v[134:135], v[122:123], v[32:47]
L_c_48:
    s_waitcnt vmcnt(0) lgkmcnt(0)
    s_barrier
    s_cmp_eq_u32 s42, 0
    s_cbranch_scc1 L_c_49
    ds_read_b32 v121, v6
    ds_read_b32 v123, v6 offset:256
L_c_49:
    ds_read_b128 v[124:127], v160 offset:1280
    ds_read_b32 v132, v161 offset:2304
    s_mov_b64 exec, s[4:5]
    ds_read_b128 v[136:139], v152 offset:0
    ds_read_b128 v[140:143], v152 offset:640
    s_mov_b64 exec, -1
    s_cmp_eq_u32 s42, 0
    s_cbranch_scc1 L_c_50
    s_waitcnt lgkmcnt(4)
    v_mfma_f32_32x32x16_bf16 v[16:31], v[128:131], v[112:115], 0
    v_mfma_f32_32x32x8_bf16 v[16:31], v[134:135], v[120:121], v[16:31]
    v_mfma_f32_32x32x16_bf16 v[32:47], v[128:131], v[116:119], 0
    v_mfma_f32_32x32x8_bf16 v[32:47], v[134:135], v[122:123], v[32:47]
L_c_50:
    s_nop 4
    s_cmp_eq_u32 s42, 0
    s_cbranch_scc0 L_b_k2
    ds_read_b32 v252, v194 offset:256
    s_branch L_b_done
L_b_k2:
    ds_read_b64_tr_b16 v[168:169], v197 offset:0
    ds_read_b64_tr_b16 v[172:173], v198 offset:0
    ds_read_b64_tr_b16 v[170:171], v197 offset:1088
    ds_read_b64_tr_b16 v[174:175], v198 offset:1088
    ds_read_b64_tr_b16 v[176:177], v197 offset:4352
    ds_read_b64_tr_b16 v[180:181], v198 offset:4352
    ds_read_b64_tr_b16 v[178:179], v197 offset:5440
    ds_read_b64_tr_b16 v[182:183], v198 offset:5440
    ds_read_b64_tr_b16 v[184:185], v197 offset:8704
    ds_read_b64_tr_b16 v[188:189], v198 offset:8704
    ds_read_b64_tr_b16 v[186:187], v197 offset:9792
    ds_read_b64_tr_b16 v[190:191], v198 offset:9792
    s_waitcnt lgkmcnt(8)
    v_mfma_f32_32x32x16_bf16 v[200:215], v[168:171], v[172:175], 0
    ds_read_b64_tr_b16 v[168:169], v197 offset:13056
    ds_read_b64_tr_b16 v[172:173], v198 offset:13056
    ds_read_b64_tr_b16 v[170:171], v197 offset:14144
    ds_read_b64_tr_b16 v[174:175], v198 offset:14144
    s_waitcnt lgkmcnt(8)
    v_mfma_f32_32x32x16_bf16 v[200:215], v[176:179], v[180:183], v[200:215]
    ds_read_b64_tr_b16 v[176:177], v197 offset:17408
    ds_read_b64_tr_b16 v[180:181], v198 offset:17408
    ds_read_b64_tr_b16 v[178:179], v197 offset:18496
    ds_read_b64_tr_b16 v[182:183], v198 offset:18496
    s_waitcnt lgkmcnt(8)
    v_mfma_f32_32x32x16_bf16 v[200:215], v[184:187], v[188:191], v[200:215]
    ds_read_b64_tr_b16 v[184:185], v197 offset:21760
    ds_read_b64_tr_b16 v[188:189], v198 offset:21760
    ds_read_b64_tr_b16 v[186:187], v197 offset:22848
    ds_read_b64_tr_b16 v[190:191], v198 offset:22848
    s_waitcnt lgkmcnt(8)
    v_mfma_f32_32x32x16_bf16 v[200:215], v[168:171], v[172:175], v[200:215]
    ds_read_b64_tr_b16 v[168:169], v197 offset:26112
    ds_read_b64_tr_b16 v[172:173], v198 offset:26112
    ds_read_b64_tr_b16 v[170:171], v197 offset:27200
    ds_read_b64_tr_b16 v[174:175], v198 offset:27200
    s_waitcnt lgkmcnt(8)
    v_mfma_f32_32x32x16_bf16 v[200:215], v[176:179], v[180:183], v[200:215]
    ds_read_b64_tr_b16 v[176:177], v197 offset:30464
    ds_read_b64_tr_b16 v[180:181], v198 offset:30464
    ds_read_b64_tr_b16 v[178:179], v197 offset:31552
    ds_read_b64_tr_b16 v[182:183], v198 offset:31552
    s_waitcnt lgkmcnt(8)
    v_mfma_f32_32x32x16_bf16 v[200:215], v[184:187], v[188:191], v[200:215]
    s_waitcnt lgkmcnt(4)
    v_mfma_f32_32x32x16_bf16 v[200:215], v[168:171], v[172:175], v[200:215]
    s_waitcnt lgkmcnt(0)
    v_mfma_f32_32x32x16_bf16 v[200:215], v[176:179], v[180:183], v[200:215]
L_b_done:
L_at_go:
    s_setprio 3
    s_waitcnt lgkmcnt(0)
    v_exp_f32 v16, v16
    v_exp_f32 v17, v17
    s_cmp_lg_u32 s42, 0
    s_cbranch_scc1 L_h_51
    s_add_u32 m0, s70, 20480
    s_add_u32 s54, s69, 4096
    buffer_load_dwordx4 v163, s[16:19], s69 offen sc1 lds
    buffer_load_dwordx4 v163, s[16:19], s69 offen offset:1024 sc1 lds
    buffer_load_dwordx4 v163, s[16:19], s69 offen offset:2048 sc1 lds
    buffer_load_dwordx4 v163, s[16:19], s69 offen offset:3072 sc1 lds
    s_add_u32 m0, s70, 24576
    s_add_u32 s69, s69, 20480
    buffer_load_dwordx4 v163, s[16:19], s54 offen sc1 lds
    s_branch L_h_52
L_h_51:
    s_add_u32 m0, s70, 20480
    s_add_u32 s54, s69, 4096
    buffer_load_dwordx4 v163, s[16:19], s69 offen sc1 lds
    buffer_load_dwordx4 v163, s[16:19], s69 offen offset:1024 sc1 lds
    buffer_load_dwordx4 v163, s[16:19], s69 offen offset:2048 sc1 lds
    buffer_load_dwordx4 v163, s[16:19], s69 offen offset:3072 sc1 lds
    s_add_u32 m0, s70, 24576
    s_add_u32 s69, s69, 20480
    buffer_load_dwordx4 v163, s[16:19], s54 offen sc1 lds
L_h_52:
    ds_read_b128 v[128:131], v160 offset:3840
    ds_read_b32 v134, v161 offset:4864
    s_mov_b64 exec, s[4:5]
    ds_read_b128 v[144:147], v152 offset:2560
    ds_read_b128 v[148:151], v152 offset:3200
    s_mov_b64 exec, -1
    v_exp_f32 v18, v18
    v_exp_f32 v19, v19
    v_exp_f32 v20, v20
    v_exp_f32 v21, v21
    v_mfma_f32_32x32x16_bf16 v[48:63], v[124:127], v[112:115], 0
    v_exp_f32 v22, v22
    v_exp_f32 v23, v23
    v_exp_f32 v24, v24
    v_exp_f32 v25, v25
    v_smfmac_f32_32x32x32_bf16 v[80:95], v[136:139], v[16:23], v162
    v_exp_f32 v26, v26
    v_exp_f32 v27, v27
    v_exp_f32 v28, v28
    v_exp_f32 v29, v29
    v_mfma_f32_32x32x8_bf16 v[48:63], v[132:133], v[120:121], v[48:63]
    v_exp_f32 v30, v30
    v_exp_f32 v31, v31
    v_exp_f32 v32, v32
    v_exp_f32 v33, v33
    v_smfmac_f32_32x32x32_bf16 v[80:95], v[140:143], v[24:31], v162
    v_exp_f32 v34, v34
    v_exp_f32 v35, v35
    v_exp_f32 v36, v36
    v_exp_f32 v37, v37
    v_mfma_f32_32x32x16_bf16 v[64:79], v[124:127], v[116:119], 0
    v_exp_f32 v38, v38
    v_exp_f32 v39, v39
    v_exp_f32 v40, v40
    v_exp_f32 v41, v41
    v_smfmac_f32_32x32x32_bf16 v[96:111], v[136:139], v[32:39], v162
    v_exp_f32 v42, v42
    v_exp_f32 v43, v43
    v_exp_f32 v44, v44
    v_exp_f32 v45, v45
    v_mfma_f32_32x32x8_bf16 v[64:79], v[132:133], v[122:123], v[64:79]
    v_exp_f32 v46, v46
    v_exp_f32 v47, v47
    s_waitcnt lgkmcnt(0)
    v_exp_f32 v48, v48
    v_exp_f32 v49, v49
    v_smfmac_f32_32x32x32_bf16 v[96:111], v[140:143], v[40:47], v162
    s_cmp_lg_u32 s42, 0
    s_cbranch_scc1 L_h_53
    s_add_u32 m0, s70, 40960
    s_add_u32 s54, s69, 4096
    buffer_load_dwordx4 v163, s[16:19], s69 offen sc1 lds
    buffer_load_dwordx4 v163, s[16:19], s69 offen offset:1024 sc1 lds
    buffer_load_dwordx4 v163, s[16:19], s69 offen offset:2048 sc1 lds
    buffer_load_dwordx4 v163, s[16:19], s69 offen offset:3072 sc1 lds
    s_add_u32 m0, s70, 45056
    s_add_u32 s69, s69, 20480
    buffer_load_dwordx4 v163, s[16:19], s54 offen sc1 lds
    s_branch L_h_54
L_h_53:
    s_cmp_lg_u32 s68, 0
    s_cbranch_scc1 L_c_55
    buffer_atomic_add_f32 v200, v199, s[16:19], s79 offen offset:0
    buffer_atomic_add_f32 v201, v199, s[16:19], s79 offen offset:160
    buffer_atomic_add_f32 v202, v199, s[16:19], s79 offen offset:320
    buffer_atomic_add_f32 v203, v199, s[16:19], s79 offen offset:480
    buffer_atomic_add_f32 v204, v199, s[16:19], s79 offen offset:1280
    buffer_atomic_add_f32 v205, v199, s[16:19], s79 offen offset:1440
    buffer_atomic_add_f32 v206, v199, s[16:19], s79 offen offset:1600
    buffer_atomic_add_f32 v207, v199, s[16:19], s79 offen offset:1760
    buffer_atomic_add_f32 v208, v199, s[16:19], s79 offen offset:2560
    buffer_atomic_add_f32 v209, v216, s[16:19], s79 offen offset:2720
    buffer_atomic_add_f32 v210, v216, s[16:19], s79 offen offset:2880
    buffer_atomic_add_f32 v211, v216, s[16:19], s79 offen offset:3040
L_c_55:
L_h_54:
    ds_read_b128 v[124:127], v160 offset:6400
    ds_read_b32 v132, v161 offset:7424
    s_mov_b64 exec, s[4:5]
    ds_read_b128 v[136:139], v152 offset:5120
    ds_read_b128 v[140:143], v152 offset:5760
    s_mov_b64 exec, -1
    v_exp_f32 v50, v50
    v_exp_f32 v51, v51
    v_exp_f32 v52, v52
    v_exp_f32 v53, v53
    v_mfma_f32_32x32x16_bf16 v[16:31], v[128:131], v[112:115], 0
    v_exp_f32 v54, v54
    v_exp_f32 v55, v55
    v_exp_f32 v56, v56
    v_exp_f32 v57, v57
    v_smfmac_f32_32x32x32_bf16 v[80:95], v[144:147], v[48:55], v162
    v_exp_f32 v58, v58
    v_exp_f32 v59, v59
    v_exp_f32 v60, v60
    v_exp_f32 v61, v61
    v_mfma_f32_32x32x8_bf16 v[16:31], v[134:135], v[120:121], v[16:31]
    v_exp_f32 v62, v62
    v_exp_f32 v63, v63
    v_exp_f32 v64, v64
    v_exp_f32 v65, v65
    v_smfmac_f32_32x32x32_bf16 v[80:95], v[148:151], v[56:63], v162
    v_exp_f32 v66, v66
    v_exp_f32 v67, v67
    v_exp_f32 v68, v68
    v_exp_f32 v69, v69
    v_mfma_f32_32x32x16_bf16 v[32:47], v[128:131], v[116:119], 0
    v_exp_f32 v70, v70
    v_exp_f32 v71, v71
    v_exp_f32 v72, v72
    v_exp_f32 v73, v73
    v_smfmac_f32_32x32x32_bf16 v[96:111], v[144:147], v[64:71], v162
    v_exp_f32 v74, v74
    v_exp_f32 v75, v75
    v_exp_f32 v76, v76
    v_exp_f32 v77, v77
    v_mfma_f32_32x32x8_bf16 v[32:47], v[134:135], v[122:123], v[32:47]
    v_exp_f32 v78, v78
    v_exp_f32 v79, v79
    s_waitcnt lgkmcnt(0)
    v_exp_f32 v16, v16
    v_exp_f32 v17, v17
    v_smfmac_f32_32x32x32_bf16 v[96:111], v[148:151], v[72:79], v162
    s_cmp_eq_u32 s42, 0
    s_cbranch_scc1 L_c_56
    s_cmp_lg_u32 s68, 0
    s_cbranch_scc1 L_c_57
    v_mov_b64 v[8:9], -1
    v_mov_b64 v[10:11], -1
    s_mul_i32 s60, s67, 40960
    s_add_u32 s60, s60, 10813440
    s_lshl_b32 s61, s66, 9
    s_add_u32 s61, s61, s60
    s_lshl_b32 s62, s66, 7
    s_add_u32 s62, s62, s60
    buffer_store_dwordx4 v[8:11], v13, s[16:19], s61 offen sc1
    buffer_store_dwordx2 v[8:9], v14, s[16:19], s62 offen sc1
    s_add_u32 s61, s61, 40960
    s_add_u32 s62, s62, 40960
    buffer_store_dwordx4 v[8:11], v13, s[16:19], s61 offen sc1
    buffer_store_dwordx2 v[8:9], v14, s[16:19], s62 offen sc1
L_c_57:
L_c_56:
    s_setprio 2
    ds_read_b128 v[128:131], v160 offset:8960
    ds_read_b32 v134, v161 offset:9984
    s_mov_b64 exec, s[4:5]
    ds_read_b128 v[144:147], v152 offset:7680
    ds_read_b128 v[148:151], v152 offset:8320
    s_mov_b64 exec, -1
    v_exp_f32 v18, v18
    v_exp_f32 v19, v19
    v_exp_f32 v20, v20
    v_exp_f32 v21, v21
    v_mfma_f32_32x32x16_bf16 v[48:63], v[124:127], v[112:115], 0
    v_exp_f32 v22, v22
    v_exp_f32 v23, v23
    v_exp_f32 v24, v24
    v_exp_f32 v25, v25
    v_smfmac_f32_32x32x32_bf16 v[80:95], v[136:139], v[16:23], v162
    v_exp_f32 v26, v26
    v_exp_f32 v27, v27
    v_exp_f32 v28, v28
    v_exp_f32 v29, v29
    v_mfma_f32_32x32x8_bf16 v[48:63], v[132:133], v[120:121], v[48:63]
    v_exp_f32 v30, v30
    v_exp_f32 v31, v31
    v_exp_f32 v32, v32
    v_exp_f32 v33, v33
    v_smfmac_f32_32x32x32_bf16 v[80:95], v[140:143], v[24:31], v162
    v_exp_f32 v34, v34
    v_exp_f32 v35, v35
    v_exp_f32 v36, v36
    v_exp_f32 v37, v37
    v_mfma_f32_32x32x16_bf16 v[64:79], v[124:127], v[116:119], 0
    v_exp_f32 v38, v38
    v_exp_f32 v39, v39
    v_exp_f32 v40, v40
    v_exp_f32 v41, v41
    v_smfmac_f32_32x32x32_bf16 v[96:111], v[136:139], v[32:39], v162
    v_exp_f32 v42, v42
    v_exp_f32 v43, v43
    v_exp_f32 v44, v44
    v_exp_f32 v45, v45
    v_mfma_f32_32x32x8_bf16 v[64:79], v[132:133], v[122:123], v[64:79]
    v_exp_f32 v46, v46
    v_exp_f32 v47, v47
    s_waitcnt lgkmcnt(0)
    v_exp_f32 v48, v48
    v_exp_f32 v49, v49
    v_smfmac_f32_32x32x32_bf16 v[96:111], v[140:143], v[40:47], v162
    s_cmp_eq_u32 s42, 0
    s_cbranch_scc1 L_c_58
    s_add_u32 m0, s70, 40960
    s_add_u32 s54, s69, 4096
    buffer_load_dwordx4 v163, s[16:19], s69 offen sc1 lds
    buffer_load_dwordx4 v163, s[16:19], s69 offen offset:1024 sc1 lds
    buffer_load_dwordx4 v163, s[16:19], s69 offen offset:2048 sc1 lds
    buffer_load_dwordx4 v163, s[16:19], s69 offen offset:3072 sc1 lds
    s_add_u32 m0, s70, 45056
    s_add_u32 s69, s69, 20480
    buffer_load_dwordx4 v163, s[16:19], s54 offen sc1 lds
L_c_58:
    ds_read_b128 v[124:127], v160 offset:11520
    ds_read_b32 v132, v161 offset:12544
    s_mov_b64 exec, s[4:5]
    ds_read_b128 v[136:139], v152 offset:10240
    ds_read_b128 v[140:143], v152 offset:10880
    s_mov_b64 exec, -1
    v_exp_f32 v50, v50
    v_exp_f32 v51, v51
    v_exp_f32 v52, v52
    v_exp_f32 v53, v53
    v_mfma_f32_32x32x16_bf16 v[16:31], v[128:131], v[112:115], 0
    v_exp_f32 v54, v54
    v_exp_f32 v55, v55
    v_exp_f32 v56, v56
    v_exp_f32 v57, v57
    v_smfmac_f32_32x32x32_bf16 v[80:95], v[144:147], v[48:55], v162
    v_exp_f32 v58, v58
    v_exp_f32 v59, v59
    v_exp_f32 v60, v60
    v_exp_f32 v61, v61
    v_mfma_f32_32x32x8_bf16 v[16:31], v[134:135], v[120:121], v[16:31]
    v_exp_f32 v62, v62
    v_exp_f32 v63, v63
    v_exp_f32 v64, v64
    v_exp_f32 v65, v65
    v_smfmac_f32_32x32x32_bf16 v[80:95], v[148:151], v[56:63], v162
    v_exp_f32 v66, v66
    v_exp_f32 v67, v67
    v_exp_f32 v68, v68
    v_exp_f32 v69, v69
    v_mfma_f32_32x32x16_bf16 v[32:47], v[128:131], v[116:119], 0
    v_exp_f32 v70, v70
    v_exp_f32 v71, v71
    v_exp_f32 v72, v72
    v_exp_f32 v73, v73
    v_smfmac_f32_32x32x32_bf16 v[96:111], v[144:147], v[64:71], v162
    v_exp_f32 v74, v74
    v_exp_f32 v75, v75
    v_exp_f32 v76, v76
    v_exp_f32 v77, v77
    v_mfma_f32_32x32x8_bf16 v[32:47], v[134:135], v[122:123], v[32:47]
    v_exp_f32 v78, v78
    v_exp_f32 v79, v79
    s_waitcnt lgkmcnt(0)
    v_exp_f32 v16, v16
    v_exp_f32 v17, v17
    v_smfmac_f32_32x32x32_bf16 v[96:111], v[148:151], v[72:79], v162
    s_cmp_lg_u32 s42, 0
    s_cbranch_scc1 L_c_59
    s_load_dwordx2 s[54:55], s[0:1], 16
    s_load_dwordx2 s[56:57], s[0:1], 48
    s_load_dwordx2 s[58:59], s[0:1], 64
    s_lshl_b32 s74, s36, 2
    s_and_b32 s60, s37, 3
    s_add_u32 s74, s74, s60
    s_lshr_b32 s75, s37, 2
    s_lshl_b32 s76, s74, 1
    s_add_u32 s76, s76, s42
    s_lshl_b32 s76, s76, 1
    s_add_u32 s6, s41, s42
    s_and_b32 s6, s6, 3
    s_mul_i32 s73, s75, 204800
    s_add_u32 s73, s73, 16056320
    s_waitcnt lgkmcnt(0)
    s_mov_b32 s8, s54
    s_mov_b32 s9, s55
    s_mov_b32 s10, 0xc8000
    s_mov_b32 s11, 0x20000
    s_mov_b32 s12, s56
    s_mov_b32 s13, s57
    s_mov_b32 s14, 0xc8000
    s_mov_b32 s15, 0x20000
    s_mov_b32 s24, s58
    s_mov_b32 s25, s59
    s_mov_b32 s26, 0x280000
    s_mov_b32 s27, 0x20000
L_c_59:
    s_setprio 1
    ds_read_b128 v[128:131], v160 offset:14080
    ds_read_b32 v134, v161 offset:15104
    s_mov_b64 exec, s[4:5]
    ds_read_b128 v[144:147], v152 offset:12800
    ds_read_b128 v[148:151], v152 offset:13440
    s_mov_b64 exec, -1
    v_exp_f32 v18, v18
    v_exp_f32 v19, v19
    v_exp_f32 v20, v20
    v_exp_f32 v21, v21
    v_mfma_f32_32x32x16_bf16 v[48:63], v[124:127], v[112:115], 0
    v_exp_f32 v22, v22
    v_exp_f32 v23, v23
    v_exp_f32 v24, v24
    v_exp_f32 v25, v25
    v_smfmac_f32_32x32x32_bf16 v[80:95], v[136:139], v[16:23], v162
    v_exp_f32 v26, v26
    v_exp_f32 v27, v27
    v_exp_f32 v28, v28
    v_exp_f32 v29, v29
    v_mfma_f32_32x32x8_bf16 v[48:63], v[132:133], v[120:121], v[48:63]
    v_exp_f32 v30, v30
    v_exp_f32 v31, v31
    v_exp_f32 v32, v32
    v_exp_f32 v33, v33
    v_smfmac_f32_32x32x32_bf16 v[80:95], v[140:143], v[24:31], v162
    v_exp_f32 v34, v34
    v_exp_f32 v35, v35
    v_exp_f32 v36, v36
    v_exp_f32 v37, v37
    v_mfma_f32_32x32x16_bf16 v[64:79], v[124:127], v[116:119], 0
    v_exp_f32 v38, v38
    v_exp_f32 v39, v39
    v_exp_f32 v40, v40
    v_exp_f32 v41, v41
    v_smfmac_f32_32x32x32_bf16 v[96:111], v[136:139], v[32:39], v162
    v_exp_f32 v42, v42
    v_exp_f32 v43, v43
    v_exp_f32 v44, v44
    v_exp_f32 v45, v45
    v_mfma_f32_32x32x8_bf16 v[64:79], v[132:133], v[122:123], v[64:79]
    v_exp_f32 v46, v46
    v_exp_f32 v47, v47
    s_waitcnt lgkmcnt(0)
    v_exp_f32 v48, v48
    v_exp_f32 v49, v49
    v_smfmac_f32_32x32x32_bf16 v[96:111], v[140:143], v[40:47], v162
    s_cmp_eq_u32 s42, 0
    s_cbranch_scc1 L_c_60
    s_load_dwordx2 s[54:55], s[0:1], 16
    s_load_dwordx2 s[56:57], s[0:1], 48
    s_load_dwordx2 s[58:59], s[0:1], 64
    s_lshl_b32 s74, s36, 2
    s_and_b32 s60, s37, 3
    s_add_u32 s74, s74, s60
    s_lshr_b32 s75, s37, 2
    s_lshl_b32 s76, s74, 1
    s_add_u32 s76, s76, s42
    s_lshl_b32 s76, s76, 1
    s_add_u32 s6, s41, s42
    s_and_b32 s6, s6, 3
    s_mul_i32 s73, s75, 204800
    s_add_u32 s73, s73, 16056320
    s_waitcnt lgkmcnt(0)
    s_mov_b32 s8, s54
    s_mov_b32 s9, s55
    s_mov_b32 s10, 0xc8000
    s_mov_b32 s11, 0x20000
    s_mov_b32 s12, s56
    s_mov_b32 s13, s57
    s_mov_b32 s14, 0xc8000
    s_mov_b32 s15, 0x20000
    s_mov_b32 s24, s58
    s_mov_b32 s25, s59
    s_mov_b32 s26, 0x280000
    s_mov_b32 s27, 0x20000
L_c_60:
    ds_read_b128 v[124:127], v160 offset:16640
    ds_read_b32 v132, v161 offset:17664
    s_mov_b64 exec, s[4:5]
    ds_read_b128 v[136:139], v152 offset:15360
    ds_read_b128 v[140:143], v152 offset:16000
    s_mov_b64 exec, -1
    v_exp_f32 v50, v50
    v_exp_f32 v51, v51
    v_exp_f32 v52, v52
    v_exp_f32 v53, v53
    v_mfma_f32_32x32x16_bf16 v[16:31], v[128:131], v[112:115], 0
    v_exp_f32 v54, v54
    v_exp_f32 v55, v55
    v_exp_f32 v56, v56
    v_exp_f32 v57, v57
    v_smfmac_f32_32x32x32_bf16 v[80:95], v[144:147], v[48:55], v162
    v_exp_f32 v58, v58
    v_exp_f32 v59, v59
    v_exp_f32 v60, v60
    v_exp_f32 v61, v61
    v_mfma_f32_32x32x8_bf16 v[16:31], v[134:135], v[120:121], v[16:31]
    v_exp_f32 v62, v62
    v_exp_f32 v63, v63
    v_exp_f32 v64, v64
    v_exp_f32 v65, v65
    v_smfmac_f32_32x32x32_bf16 v[80:95], v[148:151], v[56:63], v162
    v_exp_f32 v66, v66
    v_exp_f32 v67, v67
    v_exp_f32 v68, v68
    v_exp_f32 v69, v69
    v_mfma_f32_32x32x16_bf16 v[32:47], v[128:131], v[116:119], 0
    v_exp_f32 v70, v70
    v_exp_f32 v71, v71
    v_exp_f32 v72, v72
    v_exp_f32 v73, v73
    v_smfmac_f32_32x32x32_bf16 v[96:111], v[144:147], v[64:71], v162
    v_exp_f32 v74, v74
    v_exp_f32 v75, v75
    v_exp_f32 v76, v76
    v_exp_f32 v77, v77
    v_mfma_f32_32x32x8_bf16 v[32:47], v[134:135], v[122:123], v[32:47]
    v_exp_f32 v78, v78
    v_exp_f32 v79, v79
    s_waitcnt lgkmcnt(0)
    v_exp_f32 v16, v16
    v_exp_f32 v17, v17
    v_smfmac_f32_32x32x32_bf16 v[96:111], v[148:151], v[72:79], v162
    s_cmp_eq_u32 s42, 0
    s_cbranch_scc1 L_c_61
    s_waitcnt vmcnt(0)
    s_lshl_b32 s60, s40, 6
    s_add_u32 s60, s60, s48
    s_lshl_b32 s60, s60, 4
    s_add_u32 s60, s60, 10715136
    v_mov_b32 v0, 0
    v_mov_b32 v1, s43
    s_mov_b64 exec, 1
    buffer_store_dword v1, v0, s[16:19], s60 offen sc0 sc1
    s_mov_b64 exec, -1
L_c_61:
    s_setprio 0
    ds_read_b128 v[128:131], v160 offset:19200
    ds_read_b32 v134, v161 offset:20224
    s_mov_b64 exec, s[4:5]
    ds_read_b128 v[144:147], v152 offset:17920
    ds_read_b128 v[148:151], v152 offset:18560
    s_mov_b64 exec, -1
    v_exp_f32 v18, v18
    v_exp_f32 v19, v19
    v_exp_f32 v20, v20
    v_exp_f32 v21, v21
    v_mfma_f32_32x32x16_bf16 v[48:63], v[124:127], v[112:115], 0
    v_exp_f32 v22, v22
    v_exp_f32 v23, v23
    v_exp_f32 v24, v24
    v_exp_f32 v25, v25
    v_smfmac_f32_32x32x32_bf16 v[80:95], v[136:139], v[16:23], v162
    v_exp_f32 v26, v26
    v_exp_f32 v27, v27
    v_exp_f32 v28, v28
    v_exp_f32 v29, v29
    v_mfma_f32_32x32x8_bf16 v[48:63], v[132:133], v[120:121], v[48:63]
    v_exp_f32 v30, v30
    v_exp_f32 v31, v31
    v_exp_f32 v32, v32
    v_exp_f32 v33, v33
    v_smfmac_f32_32x32x32_bf16 v[80:95], v[140:143], v[24:31], v162
    v_exp_f32 v34, v34
    v_exp_f32 v35, v35
    v_exp_f32 v36, v36
    v_exp_f32 v37, v37
    v_mfma_f32_32x32x16_bf16 v[64:79], v[124:127], v[116:119], 0
    v_exp_f32 v38, v38
    v_exp_f32 v39, v39
    v_exp_f32 v40, v40
    v_exp_f32 v41, v41
    v_smfmac_f32_32x32x32_bf16 v[96:111], v[136:139], v[32:39], v162
    v_exp_f32 v42, v42
    v_exp_f32 v43, v43
    v_exp_f32 v44, v44
    v_exp_f32 v45, v45
    v_mfma_f32_32x32x8_bf16 v[64:79], v[132:133], v[122:123], v[64:79]
    v_exp_f32 v46, v46
    v_exp_f32 v47, v47
    s_waitcnt lgkmcnt(0)
    v_exp_f32 v48, v48
    v_exp_f32 v49, v49
    v_smfmac_f32_32x32x32_bf16 v[96:111], v[140:143], v[40:47], v162
    s_cmp_lg_u32 s42, 0
    s_cbranch_scc1 L_c_62
    s_waitcnt vmcnt(0)
L_c_62:
    s_barrier
    s_cmp_lg_u32 s42, 0
    s_cbranch_scc1 L_h_63
    s_add_u32 m0, s70, 0
    s_add_u32 s54, s69, 4096
    buffer_load_dwordx4 v163, s[16:19], s69 offen sc1 lds
    buffer_load_dwordx4 v163, s[16:19], s69 offen offset:1024 sc1 lds
    buffer_load_dwordx4 v163, s[16:19], s69 offen offset:2048 sc1 lds
    buffer_load_dwordx4 v163, s[16:19], s69 offen offset:3072 sc1 lds
    s_add_u32 m0, s70, 4096
    s_add_u32 s69, s69, 20480
    buffer_load_dwordx4 v163, s[16:19], s54 offen sc1 lds
    s_branch L_h_64
L_h_63:
    s_bitcmp1_b32 s74, 2
    s_cbranch_scc1 L_wo_65
    s_mov_b32 s56, s41
    s_lshr_b32 s57, s74, 3
    s_lshl2_add_u32 s57, s57, s74
    s_and_b32 s58, s74, 28
    s_sub_u32 s57, s57, s58
    s_lshl4_add_u32 s57, s56, s57
    s_cmp_ge_u32 s57, 40
    s_cbranch_scc1 L_wo_65
    s_lshl_b32 s56, s56, 13
    s_add_u32 s56, s56, 131072
    s_sub_u32 s58, s57, 20
    s_cmp_ge_u32 s57, 20
    s_cselect_b32 s58, s58, s57
    s_sub_u32 s59, s58, 16
    s_mul_i32 s59, s59, 204800
    s_add_u32 s59, s59, 20480
    s_and_b32 s55, s58, 3
    s_lshl_b32 s55, s55, 2
    s_lshr_b32 s54, s58, 2
    s_add_u32 s55, s55, s54
    s_mul_i32 s55, s55, 51200
    s_cmp_ge_u32 s58, 16
    s_cselect_b32 s55, s59, s55
    s_movk_i32 s59, 5120
    s_cselect_b32 s58, 0, s59
    s_cselect_b32 s59, 25600, s59
    s_mul_i32 s54, s75, 160
    s_add_u32 s55, s55, s54
    v_lshrrev_b32 v6, 4, v2
    v_mul_u32_u24 v6, 1280, v6
    v_and_b32 v7, 15, v2
    v_min_u32 v7, 9, v7
    v_lshl_add_u32 v6, v7, 4, v6
    s_cmp_ge_u32 s57, 20
    s_cbranch_scc1 L_wo_66
    s_add_u32 m0, s56, 0
    s_nop 0
    buffer_load_dwordx4 v6, s[8:11], s55 offen lds
    s_add_u32 s55, s55, s59
    s_add_u32 m0, s56, 4096
    s_nop 0
    buffer_load_dwordx4 v6, s[8:11], s55 offen lds
    s_add_u32 s55, s55, s59
    s_add_u32 m0, s56, 1024
    s_nop 0
    buffer_load_dwordx4 v6, s[8:11], s55 offen lds
    s_add_u32 s55, s55, s59
    s_add_u32 m0, s56, 5120
    s_nop 0
    buffer_load_dwordx4 v6, s[8:11], s55 offen lds
    s_add_u32 s55, s55, s59
    s_add_u32 m0, s56, 2048
    s_add_u32 s55, s55, s58
    buffer_load_dwordx4 v6, s[8:11], s55 offen lds
    s_add_u32 s55, s55, s59
    s_add_u32 m0, s56, 6144
    s_nop 0
    buffer_load_dwordx4 v6, s[8:11], s55 offen lds
    s_add_u32 s55, s55, s59
    s_add_u32 m0, s56, 3072
    s_nop 0
    buffer_load_dwordx4 v6, s[8:11], s55 offen lds
    s_add_u32 s55, s55, s59
    s_add_u32 m0, s56, 7168
    s_nop 0
    buffer_load_dwordx4 v6, s[8:11], s55 offen lds
    s_branch L_wo_67
L_wo_66:
    s_add_u32 m0, s56, 0
    s_nop 0
    buffer_load_dwordx4 v6, s[12:15], s55 offen lds
    s_add_u32 s55, s55, s59
    s_add_u32 m0, s56, 4096
    s_nop 0
    buffer_load_dwordx4 v6, s[12:15], s55 offen lds
    s_add_u32 s55, s55, s59
    s_add_u32 m0, s56, 1024
    s_nop 0
    buffer_load_dwordx4 v6, s[12:15], s55 offen lds
    s_add_u32 s55, s55, s59
    s_add_u32 m0, s56, 5120
    s_nop 0
    buffer_load_dwordx4 v6, s[12:15], s55 offen lds
    s_add_u32 s55, s55, s59
    s_add_u32 m0, s56, 2048
    s_add_u32 s55, s55, s58
    buffer_load_dwordx4 v6, s[12:15], s55 offen lds
    s_add_u32 s55, s55, s59
    s_add_u32 m0, s56, 6144
    s_nop 0
    buffer_load_dwordx4 v6, s[12:15], s55 offen lds
    s_add_u32 s55, s55, s59
    s_add_u32 m0, s56, 3072
    s_nop 0
    buffer_load_dwordx4 v6, s[12:15], s55 offen lds
    s_add_u32 s55, s55, s59
    s_add_u32 m0, s56, 7168
    s_nop 0
    buffer_load_dwordx4 v6, s[12:15], s55 offen lds
L_wo_67:
L_wo_65:
L_h_64:
    s_setprio 3
    ds_read_b128 v[124:127], v160 offset:21760
    ds_read_b32 v132, v161 offset:22784
    s_mov_b64 exec, s[4:5]
    ds_read_b128 v[136:139], v152 offset:20480
    ds_read_b128 v[140:143], v152 offset:21120
    s_mov_b64 exec, -1
    v_exp_f32 v50, v50
    v_exp_f32 v51, v51
    v_exp_f32 v52, v52
    v_exp_f32 v53, v53
    v_mfma_f32_32x32x16_bf16 v[16:31], v[128:131], v[112:115], 0
    v_exp_f32 v54, v54
    v_exp_f32 v55, v55
    v_exp_f32 v56, v56
    v_exp_f32 v57, v57
    v_smfmac_f32_32x32x32_bf16 v[80:95], v[144:147], v[48:55], v162
    v_exp_f32 v58, v58
    v_exp_f32 v59, v59
    v_exp_f32 v60, v60
    v_exp_f32 v61, v61
    v_mfma_f32_32x32x8_bf16 v[16:31], v[134:135], v[120:121], v[16:31]
    v_exp_f32 v62, v62
    v_exp_f32 v63, v63
    v_exp_f32 v64, v64
    v_exp_f32 v65, v65
    v_smfmac_f32_32x32x32_bf16 v[80:95], v[148:151], v[56:63], v162
    v_exp_f32 v66, v66
    v_exp_f32 v67, v67
    v_exp_f32 v68, v68
    v_exp_f32 v69, v69
    v_mfma_f32_32x32x16_bf16 v[32:47], v[128:131], v[116:119], 0
    v_exp_f32 v70, v70
    v_exp_f32 v71, v71
    v_exp_f32 v72, v72
    v_exp_f32 v73, v73
    v_smfmac_f32_32x32x32_bf16 v[96:111], v[144:147], v[64:71], v162
    v_exp_f32 v74, v74
    v_exp_f32 v75, v75
    v_exp_f32 v76, v76
    v_exp_f32 v77, v77
    v_mfma_f32_32x32x8_bf16 v[32:47], v[134:135], v[122:123], v[32:47]
    v_exp_f32 v78, v78
    v_exp_f32 v79, v79
    s_waitcnt lgkmcnt(0)
    v_exp_f32 v16, v16
    v_exp_f32 v17, v17
    v_smfmac_f32_32x32x32_bf16 v[96:111], v[148:151], v[72:79], v162
    s_cmp_eq_u32 s42, 0
    s_cbranch_scc1 L_c_68
    s_add_u32 m0, s70, 0
    s_add_u32 s54, s69, 4096
    buffer_load_dwordx4 v163, s[16:19], s69 offen sc1 lds
    buffer_load_dwordx4 v163, s[16:19], s69 offen offset:1024 sc1 lds
    buffer_load_dwordx4 v163, s[16:19], s69 offen offset:2048 sc1 lds
    buffer_load_dwordx4 v163, s[16:19], s69 offen offset:3072 sc1 lds
    s_add_u32 m0, s70, 4096
    s_add_u32 s69, s69, 20480
    buffer_load_dwordx4 v163, s[16:19], s54 offen sc1 lds
L_c_68:
    ds_read_b128 v[128:131], v160 offset:24320
    ds_read_b32 v134, v161 offset:25344
    s_mov_b64 exec, s[4:5]
    ds_read_b128 v[144:147], v152 offset:23040
    ds_read_b128 v[148:151], v152 offset:23680
    s_mov_b64 exec, -1
    v_exp_f32 v18, v18
    v_exp_f32 v19, v19
    v_exp_f32 v20, v20
    v_exp_f32 v21, v21
    v_mfma_f32_32x32x16_bf16 v[48:63], v[124:127], v[112:115], 0
    v_exp_f32 v22, v22
    v_exp_f32 v23, v23
    v_exp_f32 v24, v24
    v_exp_f32 v25, v25
    v_smfmac_f32_32x32x32_bf16 v[80:95], v[136:139], v[16:23], v162
    v_exp_f32 v26, v26
    v_exp_f32 v27, v27
    v_exp_f32 v28, v28
    v_exp_f32 v29, v29
    v_mfma_f32_32x32x8_bf16 v[48:63], v[132:133], v[120:121], v[48:63]
    v_exp_f32 v30, v30
    v_exp_f32 v31, v31
    v_exp_f32 v32, v32
    v_exp_f32 v33, v33
    v_smfmac_f32_32x32x32_bf16 v[80:95], v[140:143], v[24:31], v162
    v_exp_f32 v34, v34
    v_exp_f32 v35, v35
    v_exp_f32 v36, v36
    v_exp_f32 v37, v37
    v_mfma_f32_32x32x16_bf16 v[64:79], v[124:127], v[116:119], 0
    v_exp_f32 v38, v38
    v_exp_f32 v39, v39
    v_exp_f32 v40, v40
    v_exp_f32 v41, v41
    v_smfmac_f32_32x32x32_bf16 v[96:111], v[136:139], v[32:39], v162
    v_exp_f32 v42, v42
    v_exp_f32 v43, v43
    v_exp_f32 v44, v44
    v_exp_f32 v45, v45
    v_mfma_f32_32x32x8_bf16 v[64:79], v[132:133], v[122:123], v[64:79]
    v_exp_f32 v46, v46
    v_exp_f32 v47, v47
    s_waitcnt lgkmcnt(0)
    v_exp_f32 v48, v48
    v_exp_f32 v49, v49
    v_smfmac_f32_32x32x32_bf16 v[96:111], v[140:143], v[40:47], v162
    ds_read_b128 v[124:127], v160 offset:26880
    ds_read_b32 v132, v161 offset:27904
    s_mov_b64 exec, s[4:5]
    ds_read_b128 v[136:139], v152 offset:25600
    ds_read_b128 v[140:143], v152 offset:26240
    s_mov_b64 exec, -1
    v_exp_f32 v50, v50
    v_exp_f32 v51, v51
    v_exp_f32 v52, v52
    v_exp_f32 v53, v53
    v_mfma_f32_32x32x16_bf16 v[16:31], v[128:131], v[112:115], 0
    v_exp_f32 v54, v54
    v_exp_f32 v55, v55
    v_exp_f32 v56, v56
    v_exp_f32 v57, v57
    v_smfmac_f32_32x32x32_bf16 v[80:95], v[144:147], v[48:55], v162
    v_exp_f32 v58, v58
    v_exp_f32 v59, v59
    v_exp_f32 v60, v60
    v_exp_f32 v61, v61
    v_mfma_f32_32x32x8_bf16 v[16:31], v[134:135], v[120:121], v[16:31]
    v_exp_f32 v62, v62
    v_exp_f32 v63, v63
    v_exp_f32 v64, v64
    v_exp_f32 v65, v65
    v_smfmac_f32_32x32x32_bf16 v[80:95], v[148:151], v[56:63], v162
    v_exp_f32 v66, v66
    v_exp_f32 v67, v67
    v_exp_f32 v68, v68
    v_exp_f32 v69, v69
    v_mfma_f32_32x32x16_bf16 v[32:47], v[128:131], v[116:119], 0
    v_exp_f32 v70, v70
    v_exp_f32 v71, v71
    v_exp_f32 v72, v72
    v_exp_f32 v73, v73
    v_smfmac_f32_32x32x32_bf16 v[96:111], v[144:147], v[64:71], v162
    v_exp_f32 v74, v74
    v_exp_f32 v75, v75
    v_exp_f32 v76, v76
    v_exp_f32 v77, v77
    v_mfma_f32_32x32x8_bf16 v[32:47], v[134:135], v[122:123], v[32:47]
    v_exp_f32 v78, v78
    v_exp_f32 v79, v79
    s_waitcnt lgkmcnt(0)
    v_exp_f32 v16, v16
    v_exp_f32 v17, v17
    v_smfmac_f32_32x32x32_bf16 v[96:111], v[148:151], v[72:79], v162
    s_cmp_eq_u32 s42, 0
    s_cbranch_scc1 L_c_69
    s_bitcmp1_b32 s74, 2
    s_cbranch_scc1 L_wo_70
    s_mov_b32 s56, s41
    s_lshr_b32 s57, s74, 3
    s_lshl2_add_u32 s57, s57, s74
    s_and_b32 s58, s74, 28
    s_sub_u32 s57, s57, s58
    s_lshl4_add_u32 s57, s56, s57
    s_cmp_ge_u32 s57, 40
    s_cbranch_scc1 L_wo_70
    s_lshl_b32 s56, s56, 13
    s_add_u32 s56, s56, 131072
    v_lshrrev_b32 v6, 2, v2
    v_and_b32 v7, 3, v2
    v_lshl_add_u32 v6, v6, 8, s56
    v_lshl_add_u32 v8, v7, 3, v6
    v_lshl_add_u32 v6, v7, 4, v6
    s_and_b32 s55, s75, 1
    s_lshl_b32 s54, s55, 5
    s_lshl_b32 s55, s55, 7
    v_add_u32 v6, s54, v6
    v_subrev_u32 v8, s55, v8
    s_waitcnt vmcnt(0)
    ds_read_b64_tr_b16 v[168:169], v6 offset:0
    ds_read_b64_tr_b16 v[170:171], v6 offset:4096
    ds_read_b64_tr_b16 v[172:173], v6 offset:8
    ds_read_b64_tr_b16 v[174:175], v6 offset:4104
    ds_read_b64_tr_b16 v[176:177], v6 offset:64
    ds_read_b64_tr_b16 v[178:179], v6 offset:4160
    ds_read_b64_tr_b16 v[180:181], v6 offset:72
    ds_read_b64_tr_b16 v[182:183], v6 offset:4168
    ds_read_b64_tr_b16 v[184:185], v8 offset:128
    ds_read_b64_tr_b16 v[186:187], v8 offset:4224
L_wo_70:
L_c_69:
    ds_read_b128 v[128:131], v160 offset:29440
    ds_read_b32 v134, v161 offset:30464
    s_mov_b64 exec, s[4:5]
    ds_read_b128 v[144:147], v152 offset:28160
    ds_read_b128 v[148:151], v152 offset:28800
    s_mov_b64 exec, -1
    v_exp_f32 v18, v18
    v_exp_f32 v19, v19
    v_exp_f32 v20, v20
    v_exp_f32 v21, v21
    v_mfma_f32_32x32x16_bf16 v[48:63], v[124:127], v[112:115], 0
    v_exp_f32 v22, v22
    v_exp_f32 v23, v23
    v_exp_f32 v24, v24
    v_exp_f32 v25, v25
    v_smfmac_f32_32x32x32_bf16 v[80:95], v[136:139], v[16:23], v162
    v_exp_f32 v26, v26
    v_exp_f32 v27, v27
    v_exp_f32 v28, v28
    v_exp_f32 v29, v29
    v_mfma_f32_32x32x8_bf16 v[48:63], v[132:133], v[120:121], v[48:63]
    v_exp_f32 v30, v30
    v_exp_f32 v31, v31
    v_exp_f32 v32, v32
    v_exp_f32 v33, v33
    v_smfmac_f32_32x32x32_bf16 v[80:95], v[140:143], v[24:31], v162
    v_exp_f32 v34, v34
    v_exp_f32 v35, v35
    v_exp_f32 v36, v36
    v_exp_f32 v37, v37
    v_mfma_f32_32x32x16_bf16 v[64:79], v[124:127], v[116:119], 0
    v_exp_f32 v38, v38
    v_exp_f32 v39, v39
    v_exp_f32 v40, v40
    v_exp_f32 v41, v41
    v_smfmac_f32_32x32x32_bf16 v[96:111], v[136:139], v[32:39], v162
    v_exp_f32 v42, v42
    v_exp_f32 v43, v43
    v_exp_f32 v44, v44
    v_exp_f32 v45, v45
    v_mfma_f32_32x32x8_bf16 v[64:79], v[132:133], v[122:123], v[64:79]
    v_exp_f32 v46, v46
    v_exp_f32 v47, v47
    s_waitcnt lgkmcnt(0)
    v_exp_f32 v48, v48
    v_exp_f32 v49, v49
    v_smfmac_f32_32x32x32_bf16 v[96:111], v[140:143], v[40:47], v162
    s_cmp_eq_u32 s42, 0
    s_cbranch_scc1 L_c_71
    s_bitcmp1_b32 s74, 2
    s_cbranch_scc1 L_wo_72
    s_mov_b32 s56, s41
    s_lshr_b32 s57, s74, 3
    s_lshl2_add_u32 s57, s57, s74
    s_and_b32 s58, s74, 28
    s_sub_u32 s57, s57, s58
    s_lshl4_add_u32 s57, s56, s57
    s_cmp_ge_u32 s57, 40
    s_cbranch_scc1 L_wo_72
    s_mul_i32 s55, s57, 5120
    s_add_u32 s55, s55, s73
    s_add_u32 s54, s55, 4096
    buffer_store_dwordx4 v[168:171], v3, s[16:19], s55 offen offset:0 sc1
    buffer_store_dwordx4 v[172:175], v3, s[16:19], s55 offen offset:1024 sc1
    buffer_store_dwordx4 v[176:179], v3, s[16:19], s55 offen offset:2048 sc1
    buffer_store_dwordx4 v[180:183], v3, s[16:19], s55 offen offset:3072 sc1
    buffer_store_dwordx4 v[184:187], v3, s[16:19], s54 offen offset:0 sc1
L_wo_72:
L_c_71:
    ds_read_b128 v[124:127], v160 offset:32000
    ds_read_b32 v132, v161 offset:33024
    s_mov_b64 exec, s[4:5]
    ds_read_b128 v[136:139], v152 offset:30720
    ds_read_b128 v[140:143], v152 offset:31360
    s_mov_b64 exec, -1
    v_exp_f32 v50, v50
    v_exp_f32 v51, v51
    v_exp_f32 v52, v52
    v_exp_f32 v53, v53
    v_mfma_f32_32x32x16_bf16 v[16:31], v[128:131], v[112:115], 0
    v_exp_f32 v54, v54
    v_exp_f32 v55, v55
    v_exp_f32 v56, v56
    v_exp_f32 v57, v57
    v_smfmac_f32_32x32x32_bf16 v[80:95], v[144:147], v[48:55], v162
    v_exp_f32 v58, v58
    v_exp_f32 v59, v59
    v_exp_f32 v60, v60
    v_exp_f32 v61, v61
    v_mfma_f32_32x32x8_bf16 v[16:31], v[134:135], v[120:121], v[16:31]
    v_exp_f32 v62, v62
    v_exp_f32 v63, v63
    v_exp_f32 v64, v64
    v_exp_f32 v65, v65
    v_smfmac_f32_32x32x32_bf16 v[80:95], v[148:151], v[56:63], v162
    v_exp_f32 v66, v66
    v_exp_f32 v67, v67
    v_exp_f32 v68, v68
    v_exp_f32 v69, v69
    v_mfma_f32_32x32x16_bf16 v[32:47], v[128:131], v[116:119], 0
    v_exp_f32 v70, v70
    v_exp_f32 v71, v71
    v_exp_f32 v72, v72
    v_exp_f32 v73, v73
    v_smfmac_f32_32x32x32_bf16 v[96:111], v[144:147], v[64:71], v162
    v_exp_f32 v74, v74
    v_exp_f32 v75, v75
    v_exp_f32 v76, v76
    v_exp_f32 v77, v77
    v_mfma_f32_32x32x8_bf16 v[32:47], v[134:135], v[122:123], v[32:47]
    v_exp_f32 v78, v78
    v_exp_f32 v79, v79
    s_waitcnt lgkmcnt(0)
    v_exp_f32 v16, v16
    v_exp_f32 v17, v17
    v_smfmac_f32_32x32x32_bf16 v[96:111], v[148:151], v[72:79], v162
    ds_read_b128 v[128:131], v160 offset:34560
    ds_read_b32 v134, v161 offset:35584
    s_mov_b64 exec, s[4:5]
    ds_read_b128 v[144:147], v152 offset:33280
    ds_read_b128 v[148:151], v152 offset:33920
    s_mov_b64 exec, -1
    v_exp_f32 v18, v18
    v_exp_f32 v19, v19
    v_exp_f32 v20, v20
    v_exp_f32 v21, v21
    v_mfma_f32_32x32x16_bf16 v[48:63], v[124:127], v[112:115], 0
    v_exp_f32 v22, v22
    v_exp_f32 v23, v23
    v_exp_f32 v24, v24
    v_exp_f32 v25, v25
    v_smfmac_f32_32x32x32_bf16 v[80:95], v[136:139], v[16:23], v162
    v_exp_f32 v26, v26
    v_exp_f32 v27, v27
    v_exp_f32 v28, v28
    v_exp_f32 v29, v29
    v_mfma_f32_32x32x8_bf16 v[48:63], v[132:133], v[120:121], v[48:63]
    v_exp_f32 v30, v30
    v_exp_f32 v31, v31
    v_exp_f32 v32, v32
    v_exp_f32 v33, v33
    v_smfmac_f32_32x32x32_bf16 v[80:95], v[140:143], v[24:31], v162
    v_exp_f32 v34, v34
    v_exp_f32 v35, v35
    v_exp_f32 v36, v36
    v_exp_f32 v37, v37
    v_mfma_f32_32x32x16_bf16 v[64:79], v[124:127], v[116:119], 0
    v_exp_f32 v38, v38
    v_exp_f32 v39, v39
    v_exp_f32 v40, v40
    v_exp_f32 v41, v41
    v_smfmac_f32_32x32x32_bf16 v[96:111], v[136:139], v[32:39], v162
    v_exp_f32 v42, v42
    v_exp_f32 v43, v43
    v_exp_f32 v44, v44
    v_exp_f32 v45, v45
    v_mfma_f32_32x32x8_bf16 v[64:79], v[132:133], v[122:123], v[64:79]
    v_exp_f32 v46, v46
    v_exp_f32 v47, v47
    s_waitcnt lgkmcnt(0)
    v_exp_f32 v48, v48
    v_exp_f32 v49, v49
    v_smfmac_f32_32x32x32_bf16 v[96:111], v[140:143], v[40:47], v162
    s_cmp_eq_u32 s42, 0
    s_cbranch_scc1 L_c_73
    s_bitcmp1_b32 s74, 2
    s_cbranch_scc1 L_wo_74
    s_mov_b32 s56, s41
    s_lshr_b32 s57, s74, 3
    s_lshl2_add_u32 s57, s57, s74
    s_and_b32 s58, s74, 28
    s_sub_u32 s57, s57, s58
    s_lshl4_add_u32 s57, s56, s57
    s_cmp_ge_u32 s57, 40
    s_cbranch_scc1 L_wo_74
    s_waitcnt vmcnt(0)
    s_lshl_b32 s60, s75, 6
    s_add_u32 s60, s60, s57
    s_lshl_b32 s60, s60, 4
    s_add_u32 s60, s60, 10780672
    v_mov_b32 v0, 0
    v_mov_b32 v1, s43
    s_mov_b64 exec, 1
    buffer_store_dword v1, v0, s[16:19], s60 offen sc0 sc1
    s_mov_b64 exec, -1
L_wo_74:
L_c_73:
    ds_read_b128 v[124:127], v160 offset:37120
    ds_read_b32 v132, v161 offset:38144
    s_mov_b64 exec, s[4:5]
    ds_read_b128 v[136:139], v152 offset:35840
    ds_read_b128 v[140:143], v152 offset:36480
    s_mov_b64 exec, -1
    v_exp_f32 v50, v50
    v_exp_f32 v51, v51
    v_exp_f32 v52, v52
    v_exp_f32 v53, v53
    v_mfma_f32_32x32x16_bf16 v[16:31], v[128:131], v[112:115], 0
    v_exp_f32 v54, v54
    v_exp_f32 v55, v55
    v_exp_f32 v56, v56
    v_exp_f32 v57, v57
    v_smfmac_f32_32x32x32_bf16 v[80:95], v[144:147], v[48:55], v162
    v_exp_f32 v58, v58
    v_exp_f32 v59, v59
    v_exp_f32 v60, v60
    v_exp_f32 v61, v61
    v_mfma_f32_32x32x8_bf16 v[16:31], v[134:135], v[120:121], v[16:31]
    v_exp_f32 v62, v62
    v_exp_f32 v63, v63
    v_exp_f32 v64, v64
    v_exp_f32 v65, v65
    v_smfmac_f32_32x32x32_bf16 v[80:95], v[148:151], v[56:63], v162
    v_exp_f32 v66, v66
    v_exp_f32 v67, v67
    v_exp_f32 v68, v68
    v_exp_f32 v69, v69
    v_mfma_f32_32x32x16_bf16 v[32:47], v[128:131], v[116:119], 0
    v_exp_f32 v70, v70
    v_exp_f32 v71, v71
    v_exp_f32 v72, v72
    v_exp_f32 v73, v73
    v_smfmac_f32_32x32x32_bf16 v[96:111], v[144:147], v[64:71], v162
    v_exp_f32 v74, v74
    v_exp_f32 v75, v75
    v_exp_f32 v76, v76
    v_exp_f32 v77, v77
    v_mfma_f32_32x32x8_bf16 v[32:47], v[134:135], v[122:123], v[32:47]
    v_exp_f32 v78, v78
    v_exp_f32 v79, v79
    s_waitcnt lgkmcnt(0)
    v_exp_f32 v16, v16
    v_exp_f32 v17, v17
    v_smfmac_f32_32x32x32_bf16 v[96:111], v[148:151], v[72:79], v162
    s_cmp_lg_u32 s42, 0
    s_cbranch_scc1 L_c_75
    s_lshl_b32 s60, s40, 10
    s_add_u32 s60, s60, 10715136
    v_min_u32 v0, 63, v2
    v_lshlrev_b32 v0, 4, v0
    buffer_load_dword v10, v0, s[16:19], s60 offen sc0 sc1
L_c_75:
    s_setprio 2
    ds_read_b128 v[128:131], v160 offset:39680
    ds_read_b32 v134, v161 offset:40704
    s_mov_b64 exec, s[4:5]
    ds_read_b128 v[144:147], v152 offset:38400
    ds_read_b128 v[148:151], v152 offset:39040
    s_mov_b64 exec, -1
    v_exp_f32 v18, v18
    v_exp_f32 v19, v19
    v_exp_f32 v20, v20
    v_exp_f32 v21, v21
    v_mfma_f32_32x32x16_bf16 v[48:63], v[124:127], v[112:115], 0
    v_exp_f32 v22, v22
    v_exp_f32 v23, v23
    v_exp_f32 v24, v24
    v_exp_f32 v25, v25
    v_smfmac_f32_32x32x32_bf16 v[80:95], v[136:139], v[16:23], v162
    v_exp_f32 v26, v26
    v_exp_f32 v27, v27
    v_exp_f32 v28, v28
    v_exp_f32 v29, v29
    v_mfma_f32_32x32x8_bf16 v[48:63], v[132:133], v[120:121], v[48:63]
    v_exp_f32 v30, v30
    v_exp_f32 v31, v31
    v_exp_f32 v32, v32
    v_exp_f32 v33, v33
    v_smfmac_f32_32x32x32_bf16 v[80:95], v[140:143], v[24:31], v162
    v_exp_f32 v34, v34
    v_exp_f32 v35, v35
    v_exp_f32 v36, v36
    v_exp_f32 v37, v37
    v_mfma_f32_32x32x16_bf16 v[64:79], v[124:127], v[116:119], 0
    v_exp_f32 v38, v38
    v_exp_f32 v39, v39
    v_exp_f32 v40, v40
    v_exp_f32 v41, v41
    v_smfmac_f32_32x32x32_bf16 v[96:111], v[136:139], v[32:39], v162
    v_exp_f32 v42, v42
    v_exp_f32 v43, v43
    v_exp_f32 v44, v44
    v_exp_f32 v45, v45
    v_mfma_f32_32x32x8_bf16 v[64:79], v[132:133], v[122:123], v[64:79]
    v_exp_f32 v46, v46
    v_exp_f32 v47, v47
    s_waitcnt lgkmcnt(0)
    v_exp_f32 v48, v48
    v_exp_f32 v49, v49
    v_smfmac_f32_32x32x32_bf16 v[96:111], v[140:143], v[40:47], v162
    s_cmp_lg_u32 s42, 0
    s_cbranch_scc1 L_c_76
    s_waitcnt vmcnt(0)
    v_cmp_ne_u32 vcc, s43, v10
    s_nop 3
    s_cmp_eq_u64 vcc, 0
    s_cbranch_scc1 L_fc_77
    s_lshl_b32 s60, s40, 10
    s_add_u32 s60, s60, 10715136
    v_min_u32 v0, 63, v2
    v_lshlrev_b32 v0, 4, v0
    s_mov_b32 s62, 0x200000
L_fw_78:
    buffer_load_dword v1, v0, s[16:19], s60 offen sc0 sc1
    s_waitcnt vmcnt(0)
    v_cmp_ne_u32 vcc, s43, v1
    s_nop 3
    s_cmp_eq_u64 vcc, 0
    s_cbranch_scc1 L_fwd_79
    s_sleep 10
    s_sub_u32 s62, s62, 1
    s_cmp_lg_u32 s62, 0
    s_cbranch_scc1 L_fw_78
L_fwd_79:
L_fc_77:
    s_lshl_b32 s54, s40, 13
    s_add_u32 s54, s54, 10551296
    s_add_u32 s55, s54, 4096
    v_mov_b32 v8, 2147483632
    v_cmp_ge_u32 vcc, 20, v15
    v_mul_u32_u24 v6, 160, v15
    v_lshl_add_u32 v6, v5, 5, v6
    v_cndmask_b32 v6, v8, v6, vcc
    v_cmp_gt_u32 vcc, 32, v2
    s_nop 1
    v_cndmask_b32 v7, v8, v6, vcc
    buffer_load_dwordx4 v[168:171], v6, s[16:19], s54 offen offset:0 sc0 sc1
    buffer_load_dwordx4 v[172:175], v6, s[16:19], s54 offen offset:16 sc0 sc1
    buffer_load_dwordx4 v[176:179], v6, s[16:19], s54 offen offset:64 sc0 sc1
    buffer_load_dwordx4 v[180:183], v6, s[16:19], s54 offen offset:80 sc0 sc1
    buffer_load_dwordx4 v[184:187], v7, s[16:19], s54 offen offset:128 sc0 sc1
    buffer_load_dwordx4 v[188:191], v7, s[16:19], s54 offen offset:144 sc0 sc1
    buffer_load_dwordx4 v[192:195], v6, s[16:19], s55 offen offset:0 sc0 sc1
    buffer_load_dwordx4 v[196:199], v6, s[16:19], s55 offen offset:16 sc0 sc1
    buffer_load_dwordx4 v[200:203], v6, s[16:19], s55 offen offset:64 sc0 sc1
    buffer_load_dwordx4 v[204:207], v6, s[16:19], s55 offen offset:80 sc0 sc1
    buffer_load_dwordx4 v[208:211], v7, s[16:19], s55 offen offset:128 sc0 sc1
    buffer_load_dwordx4 v[212:215], v7, s[16:19], s55 offen offset:144 sc0 sc1
L_c_76:
    ds_read_b128 v[124:127], v160 offset:42240
    ds_read_b32 v132, v161 offset:43264
    s_mov_b64 exec, s[4:5]
    ds_read_b128 v[136:139], v152 offset:40960
    ds_read_b128 v[140:143], v152 offset:41600
    s_mov_b64 exec, -1
    v_exp_f32 v50, v50
    v_exp_f32 v51, v51
    v_exp_f32 v52, v52
    v_exp_f32 v53, v53
    v_mfma_f32_32x32x16_bf16 v[16:31], v[128:131], v[112:115], 0
    v_exp_f32 v54, v54
    v_exp_f32 v55, v55
    v_exp_f32 v56, v56
    v_exp_f32 v57, v57
    v_smfmac_f32_32x32x32_bf16 v[80:95], v[144:147], v[48:55], v162
    v_exp_f32 v58, v58
    v_exp_f32 v59, v59
    v_exp_f32 v60, v60
    v_exp_f32 v61, v61
    v_mfma_f32_32x32x8_bf16 v[16:31], v[134:135], v[120:121], v[16:31]
    v_exp_f32 v62, v62
    v_exp_f32 v63, v63
    v_exp_f32 v64, v64
    v_exp_f32 v65, v65
    v_smfmac_f32_32x32x32_bf16 v[80:95], v[148:151], v[56:63], v162
    v_exp_f32 v66, v66
    v_exp_f32 v67, v67
    v_exp_f32 v68, v68
    v_exp_f32 v69, v69
    v_mfma_f32_32x32x16_bf16 v[32:47], v[128:131], v[116:119], 0
    v_exp_f32 v70, v70
    v_exp_f32 v71, v71
    v_exp_f32 v72, v72
    v_exp_f32 v73, v73
    v_smfmac_f32_32x32x32_bf16 v[96:111], v[144:147], v[64:71], v162
    v_exp_f32 v74, v74
    v_exp_f32 v75, v75
    v_exp_f32 v76, v76
    v_exp_f32 v77, v77
    v_mfma_f32_32x32x8_bf16 v[32:47], v[134:135], v[122:123], v[32:47]
    v_exp_f32 v78, v78
    v_exp_f32 v79, v79
    s_waitcnt lgkmcnt(0)
    v_exp_f32 v16, v16
    v_exp_f32 v17, v17
    v_smfmac_f32_32x32x32_bf16 v[96:111], v[148:151], v[72:79], v162
    ds_read_b128 v[128:131], v160 offset:44800
    ds_read_b32 v134, v161 offset:45824
    s_mov_b64 exec, s[4:5]
    ds_read_b128 v[144:147], v152 offset:43520
    ds_read_b128 v[148:151], v152 offset:44160
    s_mov_b64 exec, -1
    v_exp_f32 v18, v18
    v_exp_f32 v19, v19
    v_exp_f32 v20, v20
    v_exp_f32 v21, v21
    v_mfma_f32_32x32x16_bf16 v[48:63], v[124:127], v[112:115], 0
    v_exp_f32 v22, v22
    v_exp_f32 v23, v23
    v_exp_f32 v24, v24
    v_exp_f32 v25, v25
    v_smfmac_f32_32x32x32_bf16 v[80:95], v[136:139], v[16:23], v162
    v_exp_f32 v26, v26
    v_exp_f32 v27, v27
    v_exp_f32 v28, v28
    v_exp_f32 v29, v29
    v_mfma_f32_32x32x8_bf16 v[48:63], v[132:133], v[120:121], v[48:63]
    v_exp_f32 v30, v30
    v_exp_f32 v31, v31
    v_exp_f32 v32, v32
    v_exp_f32 v33, v33
    v_smfmac_f32_32x32x32_bf16 v[80:95], v[140:143], v[24:31], v162
    v_exp_f32 v34, v34
    v_exp_f32 v35, v35
    v_exp_f32 v36, v36
    v_exp_f32 v37, v37
    v_mfma_f32_32x32x16_bf16 v[64:79], v[124:127], v[116:119], 0
    v_exp_f32 v38, v38
    v_exp_f32 v39, v39
    v_exp_f32 v40, v40
    v_exp_f32 v41, v41
    v_smfmac_f32_32x32x32_bf16 v[96:111], v[136:139], v[32:39], v162
    v_exp_f32 v42, v42
    v_exp_f32 v43, v43
    v_exp_f32 v44, v44
    v_exp_f32 v45, v45
    v_mfma_f32_32x32x8_bf16 v[64:79], v[132:133], v[122:123], v[64:79]
    v_exp_f32 v46, v46
    v_exp_f32 v47, v47
    s_waitcnt lgkmcnt(0)
    v_exp_f32 v48, v48
    v_exp_f32 v49, v49
    v_smfmac_f32_32x32x32_bf16 v[96:111], v[140:143], v[40:47], v162
    ds_read_b128 v[124:127], v160 offset:47360
    ds_read_b32 v132, v161 offset:48384
    s_mov_b64 exec, s[4:5]
    ds_read_b128 v[136:139], v152 offset:46080
    ds_read_b128 v[140:143], v152 offset:46720
    s_mov_b64 exec, -1
    v_exp_f32 v50, v50
    v_exp_f32 v51, v51
    v_exp_f32 v52, v52
    v_exp_f32 v53, v53
    v_mfma_f32_32x32x16_bf16 v[16:31], v[128:131], v[112:115], 0
    v_exp_f32 v54, v54
    v_exp_f32 v55, v55
    v_exp_f32 v56, v56
    v_exp_f32 v57, v57
    v_smfmac_f32_32x32x32_bf16 v[80:95], v[144:147], v[48:55], v162
    v_exp_f32 v58, v58
    v_exp_f32 v59, v59
    v_exp_f32 v60, v60
    v_exp_f32 v61, v61
    v_mfma_f32_32x32x8_bf16 v[16:31], v[134:135], v[120:121], v[16:31]
    v_exp_f32 v62, v62
    v_exp_f32 v63, v63
    v_exp_f32 v64, v64
    v_exp_f32 v65, v65
    v_smfmac_f32_32x32x32_bf16 v[80:95], v[148:151], v[56:63], v162
    v_exp_f32 v66, v66
    v_exp_f32 v67, v67
    v_exp_f32 v68, v68
    v_exp_f32 v69, v69
    v_mfma_f32_32x32x16_bf16 v[32:47], v[128:131], v[116:119], 0
    v_exp_f32 v70, v70
    v_exp_f32 v71, v71
    v_exp_f32 v72, v72
    v_exp_f32 v73, v73
    v_smfmac_f32_32x32x32_bf16 v[96:111], v[144:147], v[64:71], v162
    v_exp_f32 v74, v74
    v_exp_f32 v75, v75
    v_exp_f32 v76, v76
    v_exp_f32 v77, v77
    v_mfma_f32_32x32x8_bf16 v[32:47], v[134:135], v[122:123], v[32:47]
    v_exp_f32 v78, v78
    v_exp_f32 v79, v79
    s_waitcnt lgkmcnt(0)
    v_exp_f32 v16, v16
    v_exp_f32 v17, v17
    v_smfmac_f32_32x32x32_bf16 v[96:111], v[148:151], v[72:79], v162
    s_cmp_lg_u32 s42, 0
    s_cbranch_scc1 L_h_80
    s_cmp_lg_u32 s68, 0
    s_cbranch_scc1 L_c_82
    s_waitcnt vmcnt(0)
    v_cvt_pk_bf16_f32 v168, v168, v169
    v_cvt_pk_bf16_f32 v169, v170, v171
    v_cvt_pk_bf16_f32 v170, v172, v173
    v_cvt_pk_bf16_f32 v171, v174, v175
    v_cvt_pk_bf16_f32 v172, v176, v177
    v_cvt_pk_bf16_f32 v173, v178, v179
    v_cvt_pk_bf16_f32 v174, v180, v181
    v_cvt_pk_bf16_f32 v175, v182, v183
    v_cvt_pk_bf16_f32 v176, v184, v185
    v_cvt_pk_bf16_f32 v177, v186, v187
    v_cvt_pk_bf16_f32 v178, v188, v189
    v_cvt_pk_bf16_f32 v179, v190, v191
    v_cvt_pk_bf16_f32 v180, v192, v193
    v_cvt_pk_bf16_f32 v181, v194, v195
    v_cvt_pk_bf16_f32 v182, v196, v197
    v_cvt_pk_bf16_f32 v183, v198, v199
    v_cvt_pk_bf16_f32 v184, v200, v201
    v_cvt_pk_bf16_f32 v185, v202, v203
    v_cvt_pk_bf16_f32 v186, v204, v205
    v_cvt_pk_bf16_f32 v187, v206, v207
    v_cvt_pk_bf16_f32 v188, v208, v209
    v_cvt_pk_bf16_f32 v189, v210, v211
    v_cvt_pk_bf16_f32 v190, v212, v213
    v_cvt_pk_bf16_f32 v191, v214, v215
    s_nop 1
    v_mfma_f32_32x32x16_bf16 v[192:207], v[168:171], v[228:231], 0
    v_mfma_f32_32x32x16_bf16 v[192:207], v[172:175], v[236:239], v[192:207]
    v_mfma_f32_32x32x16_bf16 v[192:207], v[176:179], v[244:247], v[192:207]
    v_mfma_f32_32x32x16_bf16 v[208:223], v[180:183], v[232:235], 0
    v_mfma_f32_32x32x16_bf16 v[208:223], v[184:187], v[240:243], v[208:223]
    v_mfma_f32_32x32x16_bf16 v[208:223], v[188:191], v[248:251], v[208:223]
    s_lshl_b32 s58, s40, 1
    s_nop 7
    v_add_f32 v6, 0x358637bd, v204
    v_rcp_f32 v6, v6
    s_nop 0
    v_mul_f32 v6, v6, v252
    v_mov_b32 v7, v6
    v_pk_mul_f32 v[192:193], v[192:193], v[6:7]
    v_pk_mul_f32 v[194:195], v[194:195], v[6:7]
    v_pk_mul_f32 v[196:197], v[196:197], v[6:7]
    v_pk_mul_f32 v[198:199], v[198:199], v[6:7]
    v_pk_mul_f32 v[200:201], v[200:201], v[6:7]
    v_pk_mul_f32 v[202:203], v[202:203], v[6:7]
    v_cvt_pk_bf16_f32 v192, v192, v193
    v_cvt_pk_bf16_f32 v193, v194, v195
    v_cvt_pk_bf16_f32 v194, v196, v197
    v_cvt_pk_bf16_f32 v195, v198, v199
    v_cvt_pk_bf16_f32 v196, v200, v201
    v_cvt_pk_bf16_f32 v197, v202, v203
    s_mul_i32 s54, s48, 40960
    s_add_u32 s54, s54, 13434880
    s_lshl_b32 s56, s58, 9
    s_add_u32 s56, s56, s54
    s_lshl_b32 s57, s58, 7
    s_add_u32 s57, s57, s54
    buffer_store_dwordx4 v[192:195], v13, s[16:19], s56 offen sc1
    buffer_store_dwordx2 v[196:197], v14, s[16:19], s57 offen sc1
    s_add_u32 s58, s58, 1
    v_add_f32 v6, 0x358637bd, v220
    v_rcp_f32 v6, v6
    s_nop 0
    v_mul_f32 v6, v6, v252
    v_mov_b32 v7, v6
    v_pk_mul_f32 v[208:209], v[208:209], v[6:7]
    v_pk_mul_f32 v[210:211], v[210:211], v[6:7]
    v_pk_mul_f32 v[212:213], v[212:213], v[6:7]
    v_pk_mul_f32 v[214:215], v[214:215], v[6:7]
    v_pk_mul_f32 v[216:217], v[216:217], v[6:7]
    v_pk_mul_f32 v[218:219], v[218:219], v[6:7]
    v_cvt_pk_bf16_f32 v208, v208, v209
    v_cvt_pk_bf16_f32 v209, v210, v211
    v_cvt_pk_bf16_f32 v210, v212, v213
    v_cvt_pk_bf16_f32 v211, v214, v215
    v_cvt_pk_bf16_f32 v212, v216, v217
    v_cvt_pk_bf16_f32 v213, v218, v219
    s_mul_i32 s54, s48, 40960
    s_add_u32 s54, s54, 13434880
    s_lshl_b32 s56, s58, 9
    s_add_u32 s56, s56, s54
    s_lshl_b32 s57, s58, 7
    s_add_u32 s57, s57, s54
    buffer_store_dwordx4 v[208:211], v13, s[16:19], s56 offen sc1
    buffer_store_dwordx2 v[212:213], v14, s[16:19], s57 offen sc1
L_c_82:
    s_branch L_h_81
L_h_80:
    v_and_b32 v6, 15, v2
    s_lshr_b32 s54, s6, 1
    s_add_u32 s54, s54, s76
    s_lshl_b32 s54, s54, 4
    v_add_u32 v6, s54, v6
    v_mul_u32_u24 v6, 1280, v6
    v_and_b32 v7, 48, v2
    s_mul_i32 s54, s75, 160
    v_add3_u32 v214, v6, v7, s54
    v_lshrrev_b32 v7, 1, v7
    v_sub_u32 v215, v214, v7
    s_and_b32 s55, s75, 1
    s_lshl_b32 s54, s55, 5
    s_lshl_b32 s55, s55, 7
    v_add_u32 v214, s54, v214
    v_subrev_u32 v215, s55, v215
    v_lshrrev_b32 v6, 4, v2
    v_and_b32 v7, 15, v2
    v_lshlrev_b32 v7, 3, v7
    v_lshl_add_u32 v6, v6, 8, v7
    s_mul_i32 s54, s6, 3072
    s_sub_u32 s54, 16384, s54
    v_add_u32 v213, s54, v6
    s_mul_i32 s54, s6, 5120
    v_add_u32 v208, s54, v3
    v_add_u32 v209, 57344, v208
    v_add_u32 v210, 114688, v208
    s_mul_i32 s54, s76, 20480
    s_lshl_b32 s55, s6, 10
    s_add_u32 s55, s55, s54
    s_add_u32 s55, s55, 10850428
    v_and_b32 v7, 7, v2
    v_lshl_add_u32 v212, v7, 7, s55
L_h_81:
    ds_read_b128 v[128:131], v160 offset:49920
    ds_read_b32 v134, v161 offset:50944
    s_mov_b64 exec, s[4:5]
    ds_read_b128 v[144:147], v152 offset:48640
    ds_read_b128 v[148:151], v152 offset:49280
    s_mov_b64 exec, -1
    v_exp_f32 v18, v18
    v_exp_f32 v19, v19
    v_exp_f32 v20, v20
    v_exp_f32 v21, v21
    v_mfma_f32_32x32x16_bf16 v[48:63], v[124:127], v[112:115], 0
    v_exp_f32 v22, v22
    v_exp_f32 v23, v23
    v_exp_f32 v24, v24
    v_exp_f32 v25, v25
    v_smfmac_f32_32x32x32_bf16 v[80:95], v[136:139], v[16:23], v162
    v_exp_f32 v26, v26
    v_exp_f32 v27, v27
    v_exp_f32 v28, v28
    v_exp_f32 v29, v29
    v_mfma_f32_32x32x8_bf16 v[48:63], v[132:133], v[120:121], v[48:63]
    v_exp_f32 v30, v30
    v_exp_f32 v31, v31
    v_exp_f32 v32, v32
    v_exp_f32 v33, v33
    v_smfmac_f32_32x32x32_bf16 v[80:95], v[140:143], v[24:31], v162
    v_exp_f32 v34, v34
    v_exp_f32 v35, v35
    v_exp_f32 v36, v36
    v_exp_f32 v37, v37
    v_mfma_f32_32x32x16_bf16 v[64:79], v[124:127], v[116:119], 0
    v_exp_f32 v38, v38
    v_exp_f32 v39, v39
    v_exp_f32 v40, v40
    v_exp_f32 v41, v41
    v_smfmac_f32_32x32x32_bf16 v[96:111], v[136:139], v[32:39], v162
    v_exp_f32 v42, v42
    v_exp_f32 v43, v43
    v_exp_f32 v44, v44
    v_exp_f32 v45, v45
    v_mfma_f32_32x32x8_bf16 v[64:79], v[132:133], v[122:123], v[64:79]
    v_exp_f32 v46, v46
    v_exp_f32 v47, v47
    s_waitcnt lgkmcnt(0)
    v_exp_f32 v48, v48
    v_exp_f32 v49, v49
    v_smfmac_f32_32x32x32_bf16 v[96:111], v[140:143], v[40:47], v162
    s_setprio 1
    ds_read_b128 v[124:127], v160 offset:52480
    ds_read_b32 v132, v161 offset:53504
    s_mov_b64 exec, s[4:5]
    ds_read_b128 v[136:139], v152 offset:51200
    ds_read_b128 v[140:143], v152 offset:51840
    s_mov_b64 exec, -1
    v_exp_f32 v50, v50
    v_exp_f32 v51, v51
    v_exp_f32 v52, v52
    v_exp_f32 v53, v53
    v_mfma_f32_32x32x16_bf16 v[16:31], v[128:131], v[112:115], 0
    v_exp_f32 v54, v54
    v_exp_f32 v55, v55
    v_exp_f32 v56, v56
    v_exp_f32 v57, v57
    v_smfmac_f32_32x32x32_bf16 v[80:95], v[144:147], v[48:55], v162
    v_exp_f32 v58, v58
    v_exp_f32 v59, v59
    v_exp_f32 v60, v60
    v_exp_f32 v61, v61
    v_mfma_f32_32x32x8_bf16 v[16:31], v[134:135], v[120:121], v[16:31]
    v_exp_f32 v62, v62
    v_exp_f32 v63, v63
    v_exp_f32 v64, v64
    v_exp_f32 v65, v65
    v_smfmac_f32_32x32x32_bf16 v[80:95], v[148:151], v[56:63], v162
    v_exp_f32 v66, v66
    v_exp_f32 v67, v67
    v_exp_f32 v68, v68
    v_exp_f32 v69, v69
    v_mfma_f32_32x32x16_bf16 v[32:47], v[128:131], v[116:119], 0
    v_exp_f32 v70, v70
    v_exp_f32 v71, v71
    v_exp_f32 v72, v72
    v_exp_f32 v73, v73
    v_smfmac_f32_32x32x32_bf16 v[96:111], v[144:147], v[64:71], v162
    v_exp_f32 v74, v74
    v_exp_f32 v75, v75
    v_exp_f32 v76, v76
    v_exp_f32 v77, v77
    v_mfma_f32_32x32x8_bf16 v[32:47], v[134:135], v[122:123], v[32:47]
    v_exp_f32 v78, v78
    v_exp_f32 v79, v79
    s_waitcnt lgkmcnt(0)
    v_exp_f32 v16, v16
    v_exp_f32 v17, v17
    v_smfmac_f32_32x32x32_bf16 v[96:111], v[148:151], v[72:79], v162
    s_cmp_lg_u32 s42, 0
    s_cbranch_scc1 L_h_83
    s_waitcnt vmcnt(0)
    s_lshl_b32 s60, s48, 4
    s_add_u32 s60, s60, s40
    s_lshl_b32 s60, s60, 4
    s_add_u32 s60, s60, 10731520
    v_mov_b32 v0, 0
    v_mov_b32 v1, s43
    s_mov_b64 exec, 1
    buffer_store_dword v1, v0, s[16:19], s60 offen sc0 sc1
    s_mov_b64 exec, -1
    s_branch L_h_84
L_h_83:
    s_lshl_b32 s60, s75, 10
    s_add_u32 s60, s60, 10780672
    v_min_u32 v0, 39, v2
    v_lshlrev_b32 v0, 4, v0
    buffer_load_dword v11, v0, s[16:19], s60 offen sc0 sc1
L_h_84:
    ds_read_b128 v[128:131], v160 offset:55040
    ds_read_b32 v134, v161 offset:56064
    s_mov_b64 exec, s[4:5]
    ds_read_b128 v[144:147], v152 offset:53760
    ds_read_b128 v[148:151], v152 offset:54400
    s_mov_b64 exec, -1
    v_exp_f32 v18, v18
    v_exp_f32 v19, v19
    v_exp_f32 v20, v20
    v_exp_f32 v21, v21
    v_mfma_f32_32x32x16_bf16 v[48:63], v[124:127], v[112:115], 0
    v_exp_f32 v22, v22
    v_exp_f32 v23, v23
    v_exp_f32 v24, v24
    v_exp_f32 v25, v25
    v_smfmac_f32_32x32x32_bf16 v[80:95], v[136:139], v[16:23], v162
    v_exp_f32 v26, v26
    v_exp_f32 v27, v27
    v_exp_f32 v28, v28
    v_exp_f32 v29, v29
    v_mfma_f32_32x32x8_bf16 v[48:63], v[132:133], v[120:121], v[48:63]
    v_exp_f32 v30, v30
    v_exp_f32 v31, v31
    v_exp_f32 v32, v32
    v_exp_f32 v33, v33
    v_smfmac_f32_32x32x32_bf16 v[80:95], v[140:143], v[24:31], v162
    v_exp_f32 v34, v34
    v_exp_f32 v35, v35
    v_exp_f32 v36, v36
    v_exp_f32 v37, v37
    v_mfma_f32_32x32x16_bf16 v[64:79], v[124:127], v[116:119], 0
    v_exp_f32 v38, v38
    v_exp_f32 v39, v39
    v_exp_f32 v40, v40
    v_exp_f32 v41, v41
    v_smfmac_f32_32x32x32_bf16 v[96:111], v[136:139], v[32:39], v162
    v_exp_f32 v42, v42
    v_exp_f32 v43, v43
    v_exp_f32 v44, v44
    v_exp_f32 v45, v45
    v_mfma_f32_32x32x8_bf16 v[64:79], v[132:133], v[122:123], v[64:79]
    v_exp_f32 v46, v46
    v_exp_f32 v47, v47
    s_waitcnt lgkmcnt(0)
    v_exp_f32 v48, v48
    v_exp_f32 v49, v49
    v_smfmac_f32_32x32x32_bf16 v[96:111], v[140:143], v[40:47], v162
    s_cmp_lg_u32 s42, 0
    s_cbranch_scc1 L_c_85
    s_lshl_b32 s60, s75, 10
    s_add_u32 s60, s60, 10780672
    v_min_u32 v0, 39, v2
    v_lshlrev_b32 v0, 4, v0
    buffer_load_dword v11, v0, s[16:19], s60 offen sc0 sc1
    v_and_b32 v6, 15, v2
    s_lshr_b32 s54, s6, 1
    s_add_u32 s54, s54, s76
    s_lshl_b32 s54, s54, 4
    v_add_u32 v6, s54, v6
    v_mul_u32_u24 v6, 1280, v6
    v_and_b32 v7, 48, v2
    s_mul_i32 s54, s75, 160
    v_add3_u32 v214, v6, v7, s54
    v_lshrrev_b32 v7, 1, v7
    v_sub_u32 v215, v214, v7
    s_and_b32 s55, s75, 1
    s_lshl_b32 s54, s55, 5
    s_lshl_b32 s55, s55, 7
    v_add_u32 v214, s54, v214
    v_subrev_u32 v215, s55, v215
    v_lshrrev_b32 v6, 4, v2
    v_and_b32 v7, 15, v2
    v_lshlrev_b32 v7, 3, v7
    v_lshl_add_u32 v6, v6, 8, v7
    s_mul_i32 s54, s6, 3072
    s_sub_u32 s54, 16384, s54
    v_add_u32 v213, s54, v6
    s_mul_i32 s54, s6, 5120
    v_add_u32 v208, s54, v3
    v_add_u32 v209, 57344, v208
    v_add_u32 v210, 114688, v208
    s_mul_i32 s54, s76, 20480
    s_lshl_b32 s55, s6, 10
    s_add_u32 s55, s55, s54
    s_add_u32 s55, s55, 10850428
    v_and_b32 v7, 7, v2
    v_lshl_add_u32 v212, v7, 7, s55
L_c_85:
    ds_read_b128 v[124:127], v160 offset:57600
    ds_read_b32 v132, v161 offset:58624
    s_mov_b64 exec, s[4:5]
    ds_read_b128 v[136:139], v152 offset:56320
    ds_read_b128 v[140:143], v152 offset:56960
    s_mov_b64 exec, -1
    v_exp_f32 v50, v50
    v_exp_f32 v51, v51
    v_exp_f32 v52, v52
    v_exp_f32 v53, v53
    v_mfma_f32_32x32x16_bf16 v[16:31], v[128:131], v[112:115], 0
    v_exp_f32 v54, v54
    v_exp_f32 v55, v55
    v_exp_f32 v56, v56
    v_exp_f32 v57, v57
    v_smfmac_f32_32x32x32_bf16 v[80:95], v[144:147], v[48:55], v162
    v_exp_f32 v58, v58
    v_exp_f32 v59, v59
    v_exp_f32 v60, v60
    v_exp_f32 v61, v61
    v_mfma_f32_32x32x8_bf16 v[16:31], v[134:135], v[120:121], v[16:31]
    v_exp_f32 v62, v62
    v_exp_f32 v63, v63
    v_exp_f32 v64, v64
    v_exp_f32 v65, v65
    v_smfmac_f32_32x32x32_bf16 v[80:95], v[148:151], v[56:63], v162
    v_exp_f32 v66, v66
    v_exp_f32 v67, v67
    v_exp_f32 v68, v68
    v_exp_f32 v69, v69
    v_mfma_f32_32x32x16_bf16 v[32:47], v[128:131], v[116:119], 0
    v_exp_f32 v70, v70
    v_exp_f32 v71, v71
    v_exp_f32 v72, v72
    v_exp_f32 v73, v73
    v_smfmac_f32_32x32x32_bf16 v[96:111], v[144:147], v[64:71], v162
    v_exp_f32 v74, v74
    v_exp_f32 v75, v75
    v_exp_f32 v76, v76
    v_exp_f32 v77, v77
    v_mfma_f32_32x32x8_bf16 v[32:47], v[134:135], v[122:123], v[32:47]
    v_exp_f32 v78, v78
    v_exp_f32 v79, v79
    s_waitcnt lgkmcnt(0)
    v_exp_f32 v16, v16
    v_exp_f32 v17, v17
    v_smfmac_f32_32x32x32_bf16 v[96:111], v[148:151], v[72:79], v162
    s_cmp_lg_u32 s42, 0
    s_cbranch_scc1 L_h_86
    s_waitcnt vmcnt(0)
    v_cmp_ne_u32 vcc, s43, v11
    s_nop 3
    s_cmp_eq_u64 vcc, 0
    s_cbranch_scc1 L_fc_88
    s_lshl_b32 s60, s75, 10
    s_add_u32 s60, s60, 10780672
    v_min_u32 v0, 39, v2
    v_lshlrev_b32 v0, 4, v0
    s_mov_b32 s62, 0x200000
L_fw_89:
    buffer_load_dword v1, v0, s[16:19], s60 offen sc0 sc1
    s_waitcnt vmcnt(0)
    v_cmp_ne_u32 vcc, s43, v1
    s_nop 3
    s_cmp_eq_u64 vcc, 0
    s_cbranch_scc1 L_fwd_90
    s_sleep 10
    s_sub_u32 s62, s62, 1
    s_cmp_lg_u32 s62, 0
    s_cbranch_scc1 L_fw_89
L_fwd_90:
L_fc_88:
    s_mul_i32 s54, s6, 5120
    s_add_u32 s54, s54, s73
    s_add_u32 s54, s54, 102400
    buffer_load_dwordx4 v[216:219], v3, s[16:19], s54 offen offset:0 sc1
    buffer_load_dwordx4 v[220:223], v3, s[16:19], s54 offen offset:1024 sc1
    buffer_load_dwordx4 v[224:227], v3, s[16:19], s54 offen offset:2048 sc1
    buffer_load_dwordx4 v[228:231], v3, s[16:19], s54 offen offset:3072 sc1
    s_add_u32 s54, s54, 4096
    buffer_load_dwordx4 v[232:235], v3, s[16:19], s54 offen offset:0 sc1
    s_add_u32 s54, s54, 16384
    buffer_load_dwordx4 v[236:239], v3, s[16:19], s54 offen offset:0 sc1
    buffer_load_dwordx4 v[240:243], v3, s[16:19], s54 offen offset:1024 sc1
    buffer_load_dwordx4 v[244:247], v3, s[16:19], s54 offen offset:2048 sc1
    buffer_load_dwordx4 v[248:251], v3, s[16:19], s54 offen offset:3072 sc1
    s_add_u32 s54, s54, 4096
    buffer_load_dwordx4 v[252:255], v3, s[16:19], s54 offen offset:0 sc1
    s_branch L_h_87
L_h_86:
    s_waitcnt vmcnt(0)
    v_cmp_ne_u32 vcc, s43, v11
    s_nop 3
    s_cmp_eq_u64 vcc, 0
    s_cbranch_scc1 L_fc_91
    s_lshl_b32 s60, s75, 10
    s_add_u32 s60, s60, 10780672
    v_min_u32 v0, 39, v2
    v_lshlrev_b32 v0, 4, v0
    s_mov_b32 s62, 0x200000
L_fw_92:
    buffer_load_dword v1, v0, s[16:19], s60 offen sc0 sc1
    s_waitcnt vmcnt(0)
    v_cmp_ne_u32 vcc, s43, v1
    s_nop 3
    s_cmp_eq_u64 vcc, 0
    s_cbranch_scc1 L_fwd_93
    s_sleep 10
    s_sub_u32 s62, s62, 1
    s_cmp_lg_u32 s62, 0
    s_cbranch_scc1 L_fw_92
L_fwd_93:
L_fc_91:
    s_mul_i32 s54, s6, 5120
    s_add_u32 s54, s54, s73
    s_add_u32 s54, s54, 102400
    buffer_load_dwordx4 v[216:219], v3, s[16:19], s54 offen offset:0 sc1
    buffer_load_dwordx4 v[220:223], v3, s[16:19], s54 offen offset:1024 sc1
    buffer_load_dwordx4 v[224:227], v3, s[16:19], s54 offen offset:2048 sc1
    buffer_load_dwordx4 v[228:231], v3, s[16:19], s54 offen offset:3072 sc1
    s_add_u32 s54, s54, 4096
    buffer_load_dwordx4 v[232:235], v3, s[16:19], s54 offen offset:0 sc1
    s_add_u32 s54, s54, 16384
    buffer_load_dwordx4 v[236:239], v3, s[16:19], s54 offen offset:0 sc1
    buffer_load_dwordx4 v[240:243], v3, s[16:19], s54 offen offset:1024 sc1
    buffer_load_dwordx4 v[244:247], v3, s[16:19], s54 offen offset:2048 sc1
    buffer_load_dwordx4 v[248:251], v3, s[16:19], s54 offen offset:3072 sc1
    s_add_u32 s54, s54, 4096
    buffer_load_dwordx4 v[252:255], v3, s[16:19], s54 offen offset:0 sc1
L_h_87:
    s_setprio 0
    ds_read_b128 v[128:131], v160 offset:60160
    ds_read_b32 v134, v161 offset:61184
    s_mov_b64 exec, s[4:5]
    ds_read_b128 v[144:147], v152 offset:58880
    ds_read_b128 v[148:151], v152 offset:59520
    s_mov_b64 exec, -1
    v_exp_f32 v18, v18
    v_exp_f32 v19, v19
    v_exp_f32 v20, v20
    v_exp_f32 v21, v21
    v_mfma_f32_32x32x16_bf16 v[48:63], v[124:127], v[112:115], 0
    v_exp_f32 v22, v22
    v_exp_f32 v23, v23
    v_exp_f32 v24, v24
    v_exp_f32 v25, v25
    v_smfmac_f32_32x32x32_bf16 v[80:95], v[136:139], v[16:23], v162
    v_exp_f32 v26, v26
    v_exp_f32 v27, v27
    v_exp_f32 v28, v28
    v_exp_f32 v29, v29
    v_mfma_f32_32x32x8_bf16 v[48:63], v[132:133], v[120:121], v[48:63]
    v_exp_f32 v30, v30
    v_exp_f32 v31, v31
    v_exp_f32 v32, v32
    v_exp_f32 v33, v33
    v_smfmac_f32_32x32x32_bf16 v[80:95], v[140:143], v[24:31], v162
    v_exp_f32 v34, v34
    v_exp_f32 v35, v35
    v_exp_f32 v36, v36
    v_exp_f32 v37, v37
    v_mfma_f32_32x32x16_bf16 v[64:79], v[124:127], v[116:119], 0
    v_exp_f32 v38, v38
    v_exp_f32 v39, v39
    v_exp_f32 v40, v40
    v_exp_f32 v41, v41
    v_smfmac_f32_32x32x32_bf16 v[96:111], v[136:139], v[32:39], v162
    v_exp_f32 v42, v42
    v_exp_f32 v43, v43
    v_exp_f32 v44, v44
    v_exp_f32 v45, v45
    v_mfma_f32_32x32x8_bf16 v[64:79], v[132:133], v[122:123], v[64:79]
    v_exp_f32 v46, v46
    v_exp_f32 v47, v47
    s_waitcnt lgkmcnt(0)
    v_exp_f32 v48, v48
    v_exp_f32 v49, v49
    v_smfmac_f32_32x32x32_bf16 v[96:111], v[140:143], v[40:47], v162
    s_barrier
    s_cmp_lg_u32 s42, 0
    s_cbranch_scc1 L_c_94
    s_mul_i32 s54, s38, 5120
    s_add_u32 s56, s54, 122880
    s_add_u32 s55, s38, 32
    s_mul_i32 s60, s55, 5120
    s_add_u32 m0, s56, 0
    s_add_u32 s60, s60, s73
    buffer_load_dwordx4 v3, s[16:19], s60 offen offset:0 sc1 lds
    buffer_load_dwordx4 v3, s[16:19], s60 offen offset:1024 sc1 lds
    buffer_load_dwordx4 v3, s[16:19], s60 offen offset:2048 sc1 lds
    buffer_load_dwordx4 v3, s[16:19], s60 offen offset:3072 sc1 lds
    s_add_u32 m0, s56, 4096
    s_add_u32 s60, s60, 4096
    buffer_load_dwordx4 v3, s[16:19], s60 offen offset:0 sc1 lds
L_b1_95:
L_c_94:
    s_setprio 3
    ds_read_b128 v[124:127], v160 offset:1280
    ds_read_b32 v132, v161 offset:2304
    s_mov_b64 exec, s[4:5]
    ds_read_b128 v[136:139], v152 offset:0
    ds_read_b128 v[140:143], v152 offset:640
    s_mov_b64 exec, -1
    v_exp_f32 v50, v50
    v_exp_f32 v51, v51
    v_exp_f32 v52, v52
    v_exp_f32 v53, v53
    v_mfma_f32_32x32x16_bf16 v[16:31], v[128:131], v[112:115], 0
    v_exp_f32 v54, v54
    v_exp_f32 v55, v55
    v_exp_f32 v56, v56
    v_exp_f32 v57, v57
    v_smfmac_f32_32x32x32_bf16 v[80:95], v[144:147], v[48:55], v162
    v_exp_f32 v58, v58
    v_exp_f32 v59, v59
    v_exp_f32 v60, v60
    v_exp_f32 v61, v61
    v_mfma_f32_32x32x8_bf16 v[16:31], v[134:135], v[120:121], v[16:31]
    v_exp_f32 v62, v62
    v_exp_f32 v63, v63
    v_exp_f32 v64, v64
    v_exp_f32 v65, v65
    v_smfmac_f32_32x32x32_bf16 v[80:95], v[148:151], v[56:63], v162
    v_exp_f32 v66, v66
    v_exp_f32 v67, v67
    v_exp_f32 v68, v68
    v_exp_f32 v69, v69
    v_mfma_f32_32x32x16_bf16 v[32:47], v[128:131], v[116:119], 0
    v_exp_f32 v70, v70
    v_exp_f32 v71, v71
    v_exp_f32 v72, v72
    v_exp_f32 v73, v73
    v_smfmac_f32_32x32x32_bf16 v[96:111], v[144:147], v[64:71], v162
    v_exp_f32 v74, v74
    v_exp_f32 v75, v75
    v_exp_f32 v76, v76
    v_exp_f32 v77, v77
    v_mfma_f32_32x32x8_bf16 v[32:47], v[134:135], v[122:123], v[32:47]
    v_exp_f32 v78, v78
    v_exp_f32 v79, v79
    s_waitcnt lgkmcnt(0)
    v_exp_f32 v16, v16
    v_exp_f32 v17, v17
    v_smfmac_f32_32x32x32_bf16 v[96:111], v[148:151], v[72:79], v162
    s_cmp_lg_u32 s42, 0
    s_cbranch_scc1 L_h_96
    s_mul_i32 s54, s38, 5120
    s_add_u32 s56, s54, 81920
    s_mul_i32 s55, s42, 24
    s_add_u32 s55, s55, s38
    s_mul_i32 s60, s55, 5120
    s_add_u32 m0, s56, 0
    s_add_u32 s60, s60, s73
    buffer_load_dwordx4 v3, s[16:19], s60 offen offset:0 sc1 lds
    buffer_load_dwordx4 v3, s[16:19], s60 offen offset:1024 sc1 lds
    buffer_load_dwordx4 v3, s[16:19], s60 offen offset:2048 sc1 lds
    buffer_load_dwordx4 v3, s[16:19], s60 offen offset:3072 sc1 lds
    s_add_u32 m0, s56, 4096
    s_add_u32 s60, s60, 4096
    buffer_load_dwordx4 v3, s[16:19], s60 offen offset:0 sc1 lds
L_b1_98:
    s_branch L_h_97
L_h_96:
    s_mul_i32 s54, s38, 5120
    s_add_u32 s56, s54, 122880
    s_add_u32 s55, s38, 32
    s_mul_i32 s60, s55, 5120
    s_add_u32 m0, s56, 0
    s_add_u32 s60, s60, s73
    buffer_load_dwordx4 v3, s[16:19], s60 offen offset:0 sc1 lds
    buffer_load_dwordx4 v3, s[16:19], s60 offen offset:1024 sc1 lds
    buffer_load_dwordx4 v3, s[16:19], s60 offen offset:2048 sc1 lds
    buffer_load_dwordx4 v3, s[16:19], s60 offen offset:3072 sc1 lds
    s_add_u32 m0, s56, 4096
    s_add_u32 s60, s60, 4096
    buffer_load_dwordx4 v3, s[16:19], s60 offen offset:0 sc1 lds
L_b1_99:
L_h_97:
    ds_read_b128 v[128:131], v160 offset:3840
    ds_read_b32 v134, v161 offset:4864
    s_mov_b64 exec, s[4:5]
    ds_read_b128 v[144:147], v152 offset:2560
    ds_read_b128 v[148:151], v152 offset:3200
    s_mov_b64 exec, -1
    v_exp_f32 v18, v18
    v_exp_f32 v19, v19
    v_exp_f32 v20, v20
    v_exp_f32 v21, v21
    v_mfma_f32_32x32x16_bf16 v[48:63], v[124:127], v[112:115], 0
    v_exp_f32 v22, v22
    v_exp_f32 v23, v23
    v_exp_f32 v24, v24
    v_exp_f32 v25, v25
    v_smfmac_f32_32x32x32_bf16 v[80:95], v[136:139], v[16:23], v162
    v_exp_f32 v26, v26
    v_exp_f32 v27, v27
    v_exp_f32 v28, v28
    v_exp_f32 v29, v29
    v_mfma_f32_32x32x8_bf16 v[48:63], v[132:133], v[120:121], v[48:63]
    v_exp_f32 v30, v30
    v_exp_f32 v31, v31
    v_exp_f32 v32, v32
    v_exp_f32 v33, v33
    v_smfmac_f32_32x32x32_bf16 v[80:95], v[140:143], v[24:31], v162
    v_exp_f32 v34, v34
    v_exp_f32 v35, v35
    v_exp_f32 v36, v36
    v_exp_f32 v37, v37
    v_mfma_f32_32x32x16_bf16 v[64:79], v[124:127], v[116:119], 0
    v_exp_f32 v38, v38
    v_exp_f32 v39, v39
    v_exp_f32 v40, v40
    v_exp_f32 v41, v41
    v_smfmac_f32_32x32x32_bf16 v[96:111], v[136:139], v[32:39], v162
    v_exp_f32 v42, v42
    v_exp_f32 v43, v43
    v_exp_f32 v44, v44
    v_exp_f32 v45, v45
    v_mfma_f32_32x32x8_bf16 v[64:79], v[132:133], v[122:123], v[64:79]
    v_exp_f32 v46, v46
    v_exp_f32 v47, v47
    s_waitcnt lgkmcnt(0)
    v_exp_f32 v48, v48
    v_exp_f32 v49, v49
    v_smfmac_f32_32x32x32_bf16 v[96:111], v[140:143], v[40:47], v162
    s_cmp_lg_u32 s42, 0
    s_cbranch_scc1 L_h_100
    s_mul_i32 s54, s38, 5120
    s_add_u32 s56, s54, 20480
    s_add_u32 s55, s38, 12
    s_mul_i32 s60, s55, 5120
    s_add_u32 m0, s56, 0
    s_add_u32 s60, s60, s73
    buffer_load_dwordx4 v3, s[16:19], s60 offen offset:0 sc1 lds
    buffer_load_dwordx4 v3, s[16:19], s60 offen offset:1024 sc1 lds
    buffer_load_dwordx4 v3, s[16:19], s60 offen offset:2048 sc1 lds
    buffer_load_dwordx4 v3, s[16:19], s60 offen offset:3072 sc1 lds
    s_add_u32 m0, s56, 4096
    s_add_u32 s60, s60, 4096
    buffer_load_dwordx4 v3, s[16:19], s60 offen offset:0 sc1 lds
L_b1_102:
    s_lshr_b32 s60, s76, 1
    s_lshl_b32 s60, s60, 8
    s_add_u32 s60, s60, 10731520
    v_min_u32 v0, 15, v2
    v_lshlrev_b32 v0, 4, v0
    buffer_load_dword v10, v0, s[16:19], s60 offen sc0 sc1
    s_branch L_h_101
L_h_100:
    s_mul_i32 s54, s38, 5120
    s_add_u32 s56, s54, 81920
    s_mul_i32 s55, s42, 24
    s_add_u32 s55, s55, s38
    s_mul_i32 s60, s55, 5120
    s_add_u32 m0, s56, 0
    s_add_u32 s60, s60, s73
    buffer_load_dwordx4 v3, s[16:19], s60 offen offset:0 sc1 lds
    buffer_load_dwordx4 v3, s[16:19], s60 offen offset:1024 sc1 lds
    buffer_load_dwordx4 v3, s[16:19], s60 offen offset:2048 sc1 lds
    buffer_load_dwordx4 v3, s[16:19], s60 offen offset:3072 sc1 lds
    s_add_u32 m0, s56, 4096
    s_add_u32 s60, s60, 4096
    buffer_load_dwordx4 v3, s[16:19], s60 offen offset:0 sc1 lds
L_b1_103:
L_h_101:
    ds_read_b128 v[124:127], v160 offset:6400
    ds_read_b32 v132, v161 offset:7424
    s_mov_b64 exec, s[4:5]
    ds_read_b128 v[136:139], v152 offset:5120
    ds_read_b128 v[140:143], v152 offset:5760
    s_mov_b64 exec, -1
    v_exp_f32 v50, v50
    v_exp_f32 v51, v51
    v_exp_f32 v52, v52
    v_exp_f32 v53, v53
    v_mfma_f32_32x32x16_bf16 v[16:31], v[128:131], v[112:115], 0
    v_exp_f32 v54, v54
    v_exp_f32 v55, v55
    v_exp_f32 v56, v56
    v_exp_f32 v57, v57
    v_smfmac_f32_32x32x32_bf16 v[80:95], v[144:147], v[48:55], v162
    v_exp_f32 v58, v58
    v_exp_f32 v59, v59
    v_exp_f32 v60, v60
    v_exp_f32 v61, v61
    v_mfma_f32_32x32x8_bf16 v[16:31], v[134:135], v[120:121], v[16:31]
    v_exp_f32 v62, v62
    v_exp_f32 v63, v63
    v_exp_f32 v64, v64
    v_exp_f32 v65, v65
    v_smfmac_f32_32x32x32_bf16 v[80:95], v[148:151], v[56:63], v162
    v_exp_f32 v66, v66
    v_exp_f32 v67, v67
    v_exp_f32 v68, v68
    v_exp_f32 v69, v69
    v_mfma_f32_32x32x16_bf16 v[32:47], v[128:131], v[116:119], 0
    v_exp_f32 v70, v70
    v_exp_f32 v71, v71
    v_exp_f32 v72, v72
    v_exp_f32 v73, v73
    v_smfmac_f32_32x32x32_bf16 v[96:111], v[144:147], v[64:71], v162
    v_exp_f32 v74, v74
    v_exp_f32 v75, v75
    v_exp_f32 v76, v76
    v_exp_f32 v77, v77
    v_mfma_f32_32x32x8_bf16 v[32:47], v[134:135], v[122:123], v[32:47]
    v_exp_f32 v78, v78
    v_exp_f32 v79, v79
    s_waitcnt lgkmcnt(0)
    v_exp_f32 v16, v16
    v_exp_f32 v17, v17
    v_smfmac_f32_32x32x32_bf16 v[96:111], v[148:151], v[72:79], v162
    s_cmp_lg_u32 s42, 0
    s_cbranch_scc1 L_h_104
    s_cmp_ge_u32 s38, 2
    s_cbranch_scc1 L_wot_106
    s_and_b32 s54, s74, 3
    s_lshl_b32 s54, s54, 1
    s_add_u32 s54, s54, s38
    s_mul_i32 s54, s54, 5120
    s_add_u32 s54, s54, s73
    s_add_u32 s54, s54, 20480
    v_min_u32 v6, 39, v2
    v_lshlrev_b32 v6, 7, v6
    buffer_load_dword v11, v6, s[16:19], s54 offen sc1
L_wot_106:
    s_branch L_h_105
L_h_104:
    s_mul_i32 s54, s38, 5120
    s_add_u32 s56, s54, 20480
    s_add_u32 s55, s38, 12
    s_mul_i32 s60, s55, 5120
    s_add_u32 m0, s56, 0
    s_add_u32 s60, s60, s73
    buffer_load_dwordx4 v3, s[16:19], s60 offen offset:0 sc1 lds
    buffer_load_dwordx4 v3, s[16:19], s60 offen offset:1024 sc1 lds
    buffer_load_dwordx4 v3, s[16:19], s60 offen offset:2048 sc1 lds
    buffer_load_dwordx4 v3, s[16:19], s60 offen offset:3072 sc1 lds
    s_add_u32 m0, s56, 4096
    s_add_u32 s60, s60, 4096
    buffer_load_dwordx4 v3, s[16:19], s60 offen offset:0 sc1 lds
L_b1_107:
    s_lshr_b32 s60, s76, 1
    s_lshl_b32 s60, s60, 8
    s_add_u32 s60, s60, 10731520
    v_min_u32 v0, 15, v2
    v_lshlrev_b32 v0, 4, v0
    buffer_load_dword v10, v0, s[16:19], s60 offen sc0 sc1
L_h_105:
    s_setprio 2
    ds_read_b128 v[128:131], v160 offset:8960
    ds_read_b32 v134, v161 offset:9984
    s_mov_b64 exec, s[4:5]
    ds_read_b128 v[144:147], v152 offset:7680
    ds_read_b128 v[148:151], v152 offset:8320
    s_mov_b64 exec, -1
    v_exp_f32 v18, v18
    v_exp_f32 v19, v19
    v_exp_f32 v20, v20
    v_exp_f32 v21, v21
    v_mfma_f32_32x32x16_bf16 v[48:63], v[124:127], v[112:115], 0
    v_exp_f32 v22, v22
    v_exp_f32 v23, v23
    v_exp_f32 v24, v24
    v_exp_f32 v25, v25
    v_smfmac_f32_32x32x32_bf16 v[80:95], v[136:139], v[16:23], v162
    v_exp_f32 v26, v26
    v_exp_f32 v27, v27
    v_exp_f32 v28, v28
    v_exp_f32 v29, v29
    v_mfma_f32_32x32x8_bf16 v[48:63], v[132:133], v[120:121], v[48:63]
    v_exp_f32 v30, v30
    v_exp_f32 v31, v31
    v_exp_f32 v32, v32
    v_exp_f32 v33, v33
    v_smfmac_f32_32x32x32_bf16 v[80:95], v[140:143], v[24:31], v162
    v_exp_f32 v34, v34
    v_exp_f32 v35, v35
    v_exp_f32 v36, v36
    v_exp_f32 v37, v37
    v_mfma_f32_32x32x16_bf16 v[64:79], v[124:127], v[116:119], 0
    v_exp_f32 v38, v38
    v_exp_f32 v39, v39
    v_exp_f32 v40, v40
    v_exp_f32 v41, v41
    v_smfmac_f32_32x32x32_bf16 v[96:111], v[136:139], v[32:39], v162
    v_exp_f32 v42, v42
    v_exp_f32 v43, v43
    v_exp_f32 v44, v44
    v_exp_f32 v45, v45
    v_mfma_f32_32x32x8_bf16 v[64:79], v[132:133], v[122:123], v[64:79]
    v_exp_f32 v46, v46
    v_exp_f32 v47, v47
    s_waitcnt lgkmcnt(0)
    v_exp_f32 v48, v48
    v_exp_f32 v49, v49
    v_smfmac_f32_32x32x32_bf16 v[96:111], v[140:143], v[40:47], v162
    s_cmp_lg_u32 s42, 0
    s_cbranch_scc1 L_c_108
    s_waitcnt vmcnt(0)
    v_cmp_ne_u32 vcc, s43, v10
    s_nop 3
    s_cmp_eq_u64 vcc, 0
    s_cbranch_scc1 L_fc_109
    s_lshr_b32 s60, s76, 1
    s_lshl_b32 s60, s60, 8
    s_add_u32 s60, s60, 10731520
    v_min_u32 v0, 15, v2
    v_lshlrev_b32 v0, 4, v0
    s_mov_b32 s62, 0x200000
L_fw_110:
    buffer_load_dword v1, v0, s[16:19], s60 offen sc0 sc1
    s_waitcnt vmcnt(0)
    v_cmp_ne_u32 vcc, s43, v1
    s_nop 3
    s_cmp_eq_u64 vcc, 0
    s_cbranch_scc1 L_fwd_111
    s_sleep 10
    s_sub_u32 s62, s62, 1
    s_cmp_lg_u32 s62, 0
    s_cbranch_scc1 L_fw_110
L_fwd_111:
L_fc_109:
    s_mul_i32 s54, s76, 20480
    s_lshl_b32 s55, s6, 12
    s_add_u32 s54, s54, s55
    s_add_u32 s54, s54, 13434880
    s_add_u32 s55, s54, 20480
    buffer_load_dwordx4 v[168:171], v3, s[16:19], s54 offen offset:0 sc1
    buffer_load_dwordx4 v[172:175], v3, s[16:19], s55 offen offset:0 sc1
    buffer_load_dwordx4 v[176:179], v3, s[16:19], s54 offen offset:1024 sc1
    buffer_load_dwordx4 v[180:183], v3, s[16:19], s55 offen offset:1024 sc1
    buffer_load_dwordx4 v[184:187], v3, s[16:19], s54 offen offset:2048 sc1
    buffer_load_dwordx4 v[188:191], v3, s[16:19], s55 offen offset:2048 sc1
    buffer_load_dwordx4 v[192:195], v3, s[16:19], s54 offen offset:3072 sc1
    buffer_load_dwordx4 v[196:199], v3, s[16:19], s55 offen offset:3072 sc1
    buffer_load_dwordx2 v[200:201], v213, s[16:19], s54 offen offset:0 sc1
    buffer_load_dwordx2 v[202:203], v213, s[16:19], s54 offen offset:128 sc1
    buffer_load_dwordx2 v[204:205], v213, s[16:19], s55 offen offset:0 sc1
    buffer_load_dwordx2 v[206:207], v213, s[16:19], s55 offen offset:128 sc1
    s_add_u32 s54, s67, s42
    s_lshl_b32 s54, s54, 7
    s_add_u32 s54, s54, 10682368
    v_lshlrev_b32 v6, 2, v4
    buffer_load_dword v211, v6, s[16:19], s54 offen sc1
L_c_108:
    ds_read_b128 v[124:127], v160 offset:11520
    ds_read_b32 v132, v161 offset:12544
    s_mov_b64 exec, s[4:5]
    ds_read_b128 v[136:139], v152 offset:10240
    ds_read_b128 v[140:143], v152 offset:10880
    s_mov_b64 exec, -1
    v_exp_f32 v50, v50
    v_exp_f32 v51, v51
    v_exp_f32 v52, v52
    v_exp_f32 v53, v53
    v_mfma_f32_32x32x16_bf16 v[16:31], v[128:131], v[112:115], 0
    v_exp_f32 v54, v54
    v_exp_f32 v55, v55
    v_exp_f32 v56, v56
    v_exp_f32 v57, v57
    v_smfmac_f32_32x32x32_bf16 v[80:95], v[144:147], v[48:55], v162
    v_exp_f32 v58, v58
    v_exp_f32 v59, v59
    v_exp_f32 v60, v60
    v_exp_f32 v61, v61
    v_mfma_f32_32x32x8_bf16 v[16:31], v[134:135], v[120:121], v[16:31]
    v_exp_f32 v62, v62
    v_exp_f32 v63, v63
    v_exp_f32 v64, v64
    v_exp_f32 v65, v65
    v_smfmac_f32_32x32x32_bf16 v[80:95], v[148:151], v[56:63], v162
    v_exp_f32 v66, v66
    v_exp_f32 v67, v67
    v_exp_f32 v68, v68
    v_exp_f32 v69, v69
    v_mfma_f32_32x32x16_bf16 v[32:47], v[128:131], v[116:119], 0
    v_exp_f32 v70, v70
    v_exp_f32 v71, v71
    v_exp_f32 v72, v72
    v_exp_f32 v73, v73
    v_smfmac_f32_32x32x32_bf16 v[96:111], v[144:147], v[64:71], v162
    v_exp_f32 v74, v74
    v_exp_f32 v75, v75
    v_exp_f32 v76, v76
    v_exp_f32 v77, v77
    v_mfma_f32_32x32x8_bf16 v[32:47], v[134:135], v[122:123], v[32:47]
    v_exp_f32 v78, v78
    v_exp_f32 v79, v79
    s_waitcnt lgkmcnt(0)
    v_exp_f32 v16, v16
    v_exp_f32 v17, v17
    v_smfmac_f32_32x32x32_bf16 v[96:111], v[148:151], v[72:79], v162
    s_cmp_eq_u32 s42, 0
    s_cbranch_scc1 L_c_112
    s_waitcnt vmcnt(0)
    v_cmp_ne_u32 vcc, s43, v10
    s_nop 3
    s_cmp_eq_u64 vcc, 0
    s_cbranch_scc1 L_fc_113
    s_lshr_b32 s60, s76, 1
    s_lshl_b32 s60, s60, 8
    s_add_u32 s60, s60, 10731520
    v_min_u32 v0, 15, v2
    v_lshlrev_b32 v0, 4, v0
    s_mov_b32 s62, 0x200000
L_fw_114:
    buffer_load_dword v1, v0, s[16:19], s60 offen sc0 sc1
    s_waitcnt vmcnt(0)
    v_cmp_ne_u32 vcc, s43, v1
    s_nop 3
    s_cmp_eq_u64 vcc, 0
    s_cbranch_scc1 L_fwd_115
    s_sleep 10
    s_sub_u32 s62, s62, 1
    s_cmp_lg_u32 s62, 0
    s_cbranch_scc1 L_fw_114
L_fwd_115:
L_fc_113:
    s_mul_i32 s54, s76, 20480
    s_lshl_b32 s55, s6, 12
    s_add_u32 s54, s54, s55
    s_add_u32 s54, s54, 13434880
    s_add_u32 s55, s54, 20480
    buffer_load_dwordx4 v[168:171], v3, s[16:19], s54 offen offset:0 sc1
    buffer_load_dwordx4 v[172:175], v3, s[16:19], s55 offen offset:0 sc1
    buffer_load_dwordx4 v[176:179], v3, s[16:19], s54 offen offset:1024 sc1
    buffer_load_dwordx4 v[180:183], v3, s[16:19], s55 offen offset:1024 sc1
    buffer_load_dwordx4 v[184:187], v3, s[16:19], s54 offen offset:2048 sc1
    buffer_load_dwordx4 v[188:191], v3, s[16:19], s55 offen offset:2048 sc1
    buffer_load_dwordx4 v[192:195], v3, s[16:19], s54 offen offset:3072 sc1
    buffer_load_dwordx4 v[196:199], v3, s[16:19], s55 offen offset:3072 sc1
    buffer_load_dwordx2 v[200:201], v213, s[16:19], s54 offen offset:0 sc1
    buffer_load_dwordx2 v[202:203], v213, s[16:19], s54 offen offset:128 sc1
    buffer_load_dwordx2 v[204:205], v213, s[16:19], s55 offen offset:0 sc1
    buffer_load_dwordx2 v[206:207], v213, s[16:19], s55 offen offset:128 sc1
    s_add_u32 s54, s67, s42
    s_lshl_b32 s54, s54, 7
    s_add_u32 s54, s54, 10682368
    v_lshlrev_b32 v6, 2, v4
    buffer_load_dword v211, v6, s[16:19], s54 offen sc1
L_c_112:
    s_setprio 1
    ds_read_b128 v[128:131], v160 offset:14080
    ds_read_b32 v134, v161 offset:15104
    s_mov_b64 exec, s[4:5]
    ds_read_b128 v[144:147], v152 offset:12800
    ds_read_b128 v[148:151], v152 offset:13440
    s_mov_b64 exec, -1
    v_exp_f32 v18, v18
    v_exp_f32 v19, v19
    v_exp_f32 v20, v20
    v_exp_f32 v21, v21
    v_mfma_f32_32x32x16_bf16 v[48:63], v[124:127], v[112:115], 0
    v_exp_f32 v22, v22
    v_exp_f32 v23, v23
    v_exp_f32 v24, v24
    v_exp_f32 v25, v25
    v_smfmac_f32_32x32x32_bf16 v[80:95], v[136:139], v[16:23], v162
    v_exp_f32 v26, v26
    v_exp_f32 v27, v27
    v_exp_f32 v28, v28
    v_exp_f32 v29, v29
    v_mfma_f32_32x32x8_bf16 v[48:63], v[132:133], v[120:121], v[48:63]
    v_exp_f32 v30, v30
    v_exp_f32 v31, v31
    v_exp_f32 v32, v32
    v_exp_f32 v33, v33
    v_smfmac_f32_32x32x32_bf16 v[80:95], v[140:143], v[24:31], v162
    v_exp_f32 v34, v34
    v_exp_f32 v35, v35
    v_exp_f32 v36, v36
    v_exp_f32 v37, v37
    v_mfma_f32_32x32x16_bf16 v[64:79], v[124:127], v[116:119], 0
    v_exp_f32 v38, v38
    v_exp_f32 v39, v39
    v_exp_f32 v40, v40
    v_exp_f32 v41, v41
    v_smfmac_f32_32x32x32_bf16 v[96:111], v[136:139], v[32:39], v162
    v_exp_f32 v42, v42
    v_exp_f32 v43, v43
    v_exp_f32 v44, v44
    v_exp_f32 v45, v45
    v_mfma_f32_32x32x8_bf16 v[64:79], v[132:133], v[122:123], v[64:79]
    v_exp_f32 v46, v46
    v_exp_f32 v47, v47
    s_waitcnt lgkmcnt(0)
    v_exp_f32 v48, v48
    v_exp_f32 v49, v49
    v_smfmac_f32_32x32x32_bf16 v[96:111], v[140:143], v[40:47], v162
    ds_read_b128 v[124:127], v160 offset:16640
    ds_read_b32 v132, v161 offset:17664
    s_mov_b64 exec, s[4:5]
    ds_read_b128 v[136:139], v152 offset:15360
    ds_read_b128 v[140:143], v152 offset:16000
    s_mov_b64 exec, -1
    v_exp_f32 v50, v50
    v_exp_f32 v51, v51
    v_exp_f32 v52, v52
    v_exp_f32 v53, v53
    v_mfma_f32_32x32x16_bf16 v[16:31], v[128:131], v[112:115], 0
    v_exp_f32 v54, v54
    v_exp_f32 v55, v55
    v_exp_f32 v56, v56
    v_exp_f32 v57, v57
    v_smfmac_f32_32x32x32_bf16 v[80:95], v[144:147], v[48:55], v162
    v_exp_f32 v58, v58
    v_exp_f32 v59, v59
    v_exp_f32 v60, v60
    v_exp_f32 v61, v61
    v_mfma_f32_32x32x8_bf16 v[16:31], v[134:135], v[120:121], v[16:31]
    v_exp_f32 v62, v62
    v_exp_f32 v63, v63
    v_exp_f32 v64, v64
    v_exp_f32 v65, v65
    v_smfmac_f32_32x32x32_bf16 v[80:95], v[148:151], v[56:63], v162
    v_exp_f32 v66, v66
    v_exp_f32 v67, v67
    v_exp_f32 v68, v68
    v_exp_f32 v69, v69
    v_mfma_f32_32x32x16_bf16 v[32:47], v[128:131], v[116:119], 0
    v_exp_f32 v70, v70
    v_exp_f32 v71, v71
    v_exp_f32 v72, v72
    v_exp_f32 v73, v73
    v_smfmac_f32_32x32x32_bf16 v[96:111], v[144:147], v[64:71], v162
    v_exp_f32 v74, v74
    v_exp_f32 v75, v75
    v_exp_f32 v76, v76
    v_exp_f32 v77, v77
    v_mfma_f32_32x32x8_bf16 v[32:47], v[134:135], v[122:123], v[32:47]
    v_exp_f32 v78, v78
    v_exp_f32 v79, v79
    s_waitcnt lgkmcnt(0)
    v_exp_f32 v16, v16
    v_exp_f32 v17, v17
    v_smfmac_f32_32x32x32_bf16 v[96:111], v[148:151], v[72:79], v162
    s_setprio 0
    ds_read_b128 v[128:131], v160 offset:19200
    ds_read_b32 v134, v161 offset:20224
    s_mov_b64 exec, s[4:5]
    ds_read_b128 v[144:147], v152 offset:17920
    ds_read_b128 v[148:151], v152 offset:18560
    s_mov_b64 exec, -1
    v_exp_f32 v18, v18
    v_exp_f32 v19, v19
    v_exp_f32 v20, v20
    v_exp_f32 v21, v21
    v_mfma_f32_32x32x16_bf16 v[48:63], v[124:127], v[112:115], 0
    v_exp_f32 v22, v22
    v_exp_f32 v23, v23
    v_exp_f32 v24, v24
    v_exp_f32 v25, v25
    v_smfmac_f32_32x32x32_bf16 v[80:95], v[136:139], v[16:23], v162
    v_exp_f32 v26, v26
    v_exp_f32 v27, v27
    v_exp_f32 v28, v28
    v_exp_f32 v29, v29
    v_mfma_f32_32x32x8_bf16 v[48:63], v[132:133], v[120:121], v[48:63]
    v_exp_f32 v30, v30
    v_exp_f32 v31, v31
    v_exp_f32 v32, v32
    v_exp_f32 v33, v33
    v_smfmac_f32_32x32x32_bf16 v[80:95], v[140:143], v[24:31], v162
    v_exp_f32 v34, v34
    v_exp_f32 v35, v35
    v_exp_f32 v36, v36
    v_exp_f32 v37, v37
    v_mfma_f32_32x32x16_bf16 v[64:79], v[124:127], v[116:119], 0
    v_exp_f32 v38, v38
    v_exp_f32 v39, v39
    v_exp_f32 v40, v40
    v_exp_f32 v41, v41
    v_smfmac_f32_32x32x32_bf16 v[96:111], v[136:139], v[32:39], v162
    v_exp_f32 v42, v42
    v_exp_f32 v43, v43
    v_exp_f32 v44, v44
    v_exp_f32 v45, v45
    v_mfma_f32_32x32x8_bf16 v[64:79], v[132:133], v[122:123], v[64:79]
    v_exp_f32 v46, v46
    v_exp_f32 v47, v47
    s_waitcnt lgkmcnt(0)
    v_exp_f32 v48, v48
    v_exp_f32 v49, v49
    v_smfmac_f32_32x32x32_bf16 v[96:111], v[140:143], v[40:47], v162
    s_lshl_b32 s54, s41, 12
    s_mul_i32 s55, s42, 61440
    s_add_u32 s56, s54, s55
    s_sub_u32 s55, 61440, s55
    s_add_u32 s55, s55, s54
    v_add_u32 v6, s56, v3
    v_add_u32 v7, s55, v3
    v_mov_b32 v9, 20480
    s_add_u32 s54, s67, s42
    s_mul_i32 s54, s54, 40960
    s_add_u32 s54, s54, 10813440
    s_lshl_b32 s56, s66, 9
    s_add_u32 s56, s56, s54
    s_lshl_b32 s57, s66, 7
    s_add_u32 s57, s57, s54
    s_waitcnt vmcnt(0)
    s_barrier
    ds_read_b32 v11, v9
    v_exp_f32 v50, v50
    v_exp_f32 v51, v51
    v_exp_f32 v52, v52
    v_exp_f32 v53, v53
    v_exp_f32 v54, v54
    v_exp_f32 v55, v55
    v_exp_f32 v56, v56
    v_exp_f32 v57, v57
    v_smfmac_f32_32x32x32_bf16 v[80:95], v[144:147], v[48:55], v162
    v_exp_f32 v58, v58
    v_exp_f32 v59, v59
    v_exp_f32 v60, v60
    v_exp_f32 v61, v61
    v_exp_f32 v62, v62
    v_exp_f32 v63, v63
    v_exp_f32 v64, v64
    v_exp_f32 v65, v65
    v_smfmac_f32_32x32x32_bf16 v[80:95], v[148:151], v[56:63], v162
    v_exp_f32 v66, v66
    v_exp_f32 v67, v67
    v_exp_f32 v68, v68
    v_exp_f32 v69, v69
    v_exp_f32 v70, v70
    v_exp_f32 v71, v71
    v_exp_f32 v72, v72
    v_exp_f32 v73, v73
    v_smfmac_f32_32x32x32_bf16 v[96:111], v[144:147], v[64:71], v162
    v_exp_f32 v74, v74
    v_exp_f32 v75, v75
    v_exp_f32 v76, v76
    v_exp_f32 v77, v77
    s_cmp_eq_u32 s42, 0
    s_cbranch_scc1 L_c_116
    ds_write_b128 v6, v[92:95] offset:3072
    ds_write_b128 v6, v[80:83] offset:0
    ds_write_b128 v6, v[84:87] offset:1024
    ds_write_b128 v6, v[88:91] offset:2048
L_c_116:
    v_exp_f32 v78, v78
    v_exp_f32 v79, v79
    s_cmp_lg_u32 s42, 0
    s_nop 0
    v_smfmac_f32_32x32x32_bf16 v[96:111], v[148:151], v[72:79], v162
    s_cbranch_scc1 L_at_m0
    s_nop 7
    s_nop 7
    ds_write_b128 v6, v[108:111] offset:3072
    ds_write_b128 v6, v[96:99] offset:0
    ds_write_b128 v6, v[100:103] offset:1024
    ds_write_b128 v6, v[104:107] offset:2048
    s_waitcnt lgkmcnt(0)
    s_barrier
    ds_read_b128 v[28:31], v7 offset:3072
    ds_read_b128 v[16:19], v7 offset:0
    ds_read_b128 v[20:23], v7 offset:1024
    ds_read_b128 v[24:27], v7 offset:2048
    v_mov_b32 v10, 0x4b000000
    s_nop 7
    s_nop 3
    s_waitcnt lgkmcnt(3)
    v_add_f32 v92, v92, v28
    v_rcp_f32 v6, v92
    s_waitcnt lgkmcnt(2)
    v_pk_add_f32 v[80:81], v[80:81], v[16:17]
    v_mul_f32 v6, v6, v211
    v_pk_add_f32 v[82:83], v[82:83], v[18:19]
    v_pk_add_f32 v[18:19], v[80:81], v[82:83]
    s_waitcnt lgkmcnt(1)
    v_pk_add_f32 v[84:85], v[84:85], v[20:21]
    v_pk_add_f32 v[86:87], v[86:87], v[22:23]
    v_pk_add_f32 v[22:23], v[84:85], v[86:87]
    s_waitcnt lgkmcnt(0)
    v_pk_add_f32 v[88:89], v[88:89], v[24:25]
    v_pk_add_f32 v[90:91], v[90:91], v[26:27]
    v_pk_add_f32 v[26:27], v[88:89], v[90:91]
    v_mov_b32 v7, v6
    v_pk_add_f32 v[18:19], v[18:19], v[22:23]
    v_pk_mul_f32 v[80:81], v[80:81], v[6:7]
    v_pk_add_f32 v[18:19], v[18:19], v[26:27]
    v_pk_mul_f32 v[82:83], v[82:83], v[6:7]
    v_add_f32 v18, v18, v19
    v_pk_mul_f32 v[84:85], v[84:85], v[6:7]
    v_fma_f32 v18, v18, 0, v92
    v_pk_mul_f32 v[86:87], v[86:87], v[6:7]
    v_cmp_nle_f32 vcc, v18, v10
    v_pk_mul_f32 v[88:89], v[88:89], v[6:7]
    v_pk_mul_f32 v[90:91], v[90:91], v[6:7]
    v_cvt_pk_bf16_f32 v80, v80, v81
    v_cvt_pk_bf16_f32 v81, v82, v83
    v_cvt_pk_bf16_f32 v82, v84, v85
    v_cvt_pk_bf16_f32 v83, v86, v87
    v_cvt_pk_bf16_f32 v84, v88, v89
    v_cvt_pk_bf16_f32 v85, v90, v91
    s_branch L_at_m1
L_at_m0:
    s_waitcnt lgkmcnt(0)
    s_barrier
    ds_read_b128 v[28:31], v7 offset:3072
    ds_read_b128 v[16:19], v7 offset:0
    ds_read_b128 v[20:23], v7 offset:1024
    ds_read_b128 v[24:27], v7 offset:2048
    v_mov_b32 v10, 0x4b000000
    s_nop 7
    s_nop 3
    s_waitcnt lgkmcnt(3)
    v_add_f32 v108, v108, v28
    v_rcp_f32 v6, v108
    s_waitcnt lgkmcnt(2)
    v_pk_add_f32 v[96:97], v[96:97], v[16:17]
    v_mul_f32 v6, v6, v211
    v_pk_add_f32 v[98:99], v[98:99], v[18:19]
    v_pk_add_f32 v[18:19], v[96:97], v[98:99]
    s_waitcnt lgkmcnt(1)
    v_pk_add_f32 v[100:101], v[100:101], v[20:21]
    v_pk_add_f32 v[102:103], v[102:103], v[22:23]
    v_pk_add_f32 v[22:23], v[100:101], v[102:103]
    s_waitcnt lgkmcnt(0)
    v_pk_add_f32 v[104:105], v[104:105], v[24:25]
    v_pk_add_f32 v[106:107], v[106:107], v[26:27]
    v_pk_add_f32 v[26:27], v[104:105], v[106:107]
    v_mov_b32 v7, v6
    v_pk_add_f32 v[18:19], v[18:19], v[22:23]
    v_pk_mul_f32 v[96:97], v[96:97], v[6:7]
    v_pk_add_f32 v[18:19], v[18:19], v[26:27]
    v_pk_mul_f32 v[98:99], v[98:99], v[6:7]
    v_add_f32 v18, v18, v19
    v_pk_mul_f32 v[100:101], v[100:101], v[6:7]
    v_fma_f32 v18, v18, 0, v108
    v_pk_mul_f32 v[102:103], v[102:103], v[6:7]
    v_cmp_nle_f32 vcc, v18, v10
    v_pk_mul_f32 v[104:105], v[104:105], v[6:7]
    v_pk_mul_f32 v[106:107], v[106:107], v[6:7]
    v_cvt_pk_bf16_f32 v80, v96, v97
    v_cvt_pk_bf16_f32 v81, v98, v99
    v_cvt_pk_bf16_f32 v82, v100, v101
    v_cvt_pk_bf16_f32 v83, v102, v103
    v_cvt_pk_bf16_f32 v84, v104, v105
    v_cvt_pk_bf16_f32 v85, v106, v107
L_at_m1:
    v_min_u32 v80, -2, v80
    v_min_u32 v81, -2, v81
    v_min_u32 v82, -2, v82
    v_min_u32 v83, -2, v83
    v_min_u32 v84, -2, v84
    v_min_u32 v85, -2, v85
    s_cmp_lg_u64 vcc, 0
    s_cselect_b32 s54, 1, 0
    s_andn2_b32 s54, s54, s68
    s_cbranch_scc0 L_at_st
    v_not_b32 v10, v11
    ds_write_b32 v9, v10
    s_waitcnt lgkmcnt(0)
    s_branch L_at_fin
L_at_st:
    s_bitcmp1_b32 s68, 1
    s_cbranch_scc1 L_at_fin
    buffer_store_dwordx4 v[80:83], v13, s[16:19], s56 offen sc1

    buffer_store_dwordx2 v[84:85], v14, s[16:19], s57 offen sc1
    s_bitset1_b32 s68, 1
L_at_fin:
    s_cmp_lg_u32 s42, 0
    s_cbranch_scc1 L_p5_bh
    s_barrier
    ds_read_b32 v10, v9
    v_mfma_f32_16x16x32_bf16 v[32:35], v[216:219], v[168:171], 0
    v_mfma_f32_16x16x32_bf16 v[36:39], v[220:223], v[168:171], 0
    v_mfma_f32_16x16x32_bf16 v[40:43], v[224:227], v[168:171], 0
    v_mfma_f32_16x16x32_bf16 v[44:47], v[228:231], v[168:171], 0
    v_mfma_f32_16x16x32_bf16 v[48:51], v[232:235], v[168:171], 0
    s_waitcnt lgkmcnt(0)
    v_cmp_ne_u32 vcc, v10, v11
    s_nop 3
    s_cmp_lg_u64 vcc, 0
    s_cbranch_scc1 L_at_redo
    ds_read_b128 v[96:99], v209 offset:45056
    ds_read_b128 v[100:103], v209 offset:46080
    ds_read_b128 v[104:107], v209 offset:47104
    ds_read_b128 v[108:111], v209 offset:48128
    ds_read_b128 v[112:115], v209 offset:49152
    v_mfma_f32_16x16x32_bf16 v[52:55], v[216:219], v[172:175], 0
    v_mfma_f32_16x16x32_bf16 v[56:59], v[220:223], v[172:175], 0
    v_mfma_f32_16x16x32_bf16 v[60:63], v[224:227], v[172:175], 0
    v_mfma_f32_16x16x32_bf16 v[64:67], v[228:231], v[172:175], 0
    v_mfma_f32_16x16x32_bf16 v[68:71], v[232:235], v[172:175], 0
    ds_read_b128 v[116:119], v210 offset:8192
    ds_read_b128 v[120:123], v210 offset:9216
    ds_read_b128 v[124:127], v210 offset:10240
    ds_read_b128 v[128:131], v210 offset:11264
    ds_read_b128 v[132:135], v210 offset:12288
    v_mfma_f32_16x16x32_bf16 v[32:35], v[236:239], v[176:179], v[32:35]
    v_mfma_f32_16x16x32_bf16 v[36:39], v[240:243], v[176:179], v[36:39]
    v_mfma_f32_16x16x32_bf16 v[40:43], v[244:247], v[176:179], v[40:43]
    v_mfma_f32_16x16x32_bf16 v[44:47], v[248:251], v[176:179], v[44:47]
    v_mfma_f32_16x16x32_bf16 v[48:51], v[252:255], v[176:179], v[48:51]
    ds_read_b128 v[136:139], v210 offset:28672
    ds_read_b128 v[140:143], v210 offset:29696
    ds_read_b128 v[144:147], v210 offset:30720
    ds_read_b128 v[148:151], v210 offset:31744
    ds_read_b128 v[152:155], v210 offset:32768
    v_mfma_f32_16x16x32_bf16 v[52:55], v[236:239], v[180:183], v[52:55]
    v_mfma_f32_16x16x32_bf16 v[56:59], v[240:243], v[180:183], v[56:59]
    v_mfma_f32_16x16x32_bf16 v[60:63], v[244:247], v[180:183], v[60:63]
    v_mfma_f32_16x16x32_bf16 v[64:67], v[248:251], v[180:183], v[64:67]
    v_mfma_f32_16x16x32_bf16 v[68:71], v[252:255], v[180:183], v[68:71]
    ds_read_b128 v[216:219], v209 offset:24576
    ds_read_b128 v[220:223], v209 offset:25600
    ds_read_b128 v[224:227], v209 offset:26624
    ds_read_b128 v[228:231], v209 offset:27648
    ds_read_b128 v[232:235], v209 offset:28672
    s_waitcnt lgkmcnt(10)
    v_mfma_f32_16x16x32_bf16 v[32:35], v[96:99], v[184:187], v[32:35]
    v_mfma_f32_16x16x32_bf16 v[36:39], v[100:103], v[184:187], v[36:39]
    v_mfma_f32_16x16x32_bf16 v[40:43], v[104:107], v[184:187], v[40:43]
    v_mfma_f32_16x16x32_bf16 v[44:47], v[108:111], v[184:187], v[44:47]
    v_mfma_f32_16x16x32_bf16 v[48:51], v[112:115], v[184:187], v[48:51]
    v_mfma_f32_16x16x32_bf16 v[52:55], v[96:99], v[188:191], v[52:55]
    v_mfma_f32_16x16x32_bf16 v[56:59], v[100:103], v[188:191], v[56:59]
    v_mfma_f32_16x16x32_bf16 v[60:63], v[104:107], v[188:191], v[60:63]
    v_mfma_f32_16x16x32_bf16 v[64:67], v[108:111], v[188:191], v[64:67]
    v_mfma_f32_16x16x32_bf16 v[68:71], v[112:115], v[188:191], v[68:71]
    ds_read_b128 v[236:239], v208 offset:20480
    ds_read_b128 v[240:243], v208 offset:21504
    ds_read_b128 v[244:247], v208 offset:22528
    ds_read_b128 v[248:251], v208 offset:23552
    ds_read_b128 v[252:255], v208 offset:24576
    buffer_load_dword v12, v212, s[16:19], 0 offen sc0 sc1
    s_waitcnt lgkmcnt(10)
    v_mfma_f32_16x16x32_bf16 v[32:35], v[116:119], v[192:195], v[32:35]
    v_mfma_f32_16x16x32_bf16 v[36:39], v[120:123], v[192:195], v[36:39]
    v_mfma_f32_16x16x32_bf16 v[40:43], v[124:127], v[192:195], v[40:43]
    v_mfma_f32_16x16x32_bf16 v[44:47], v[128:131], v[192:195], v[44:47]
    v_mfma_f32_16x16x32_bf16 v[48:51], v[132:135], v[192:195], v[48:51]
    s_mul_i32 s54, s76, 20480
    s_lshl_b32 s55, s6, 12
    s_add_u32 s54, s54, s55
    s_add_u32 s54, s54, 10813440
    s_add_u32 s55, s54, 20480
    s_mul_i32 s58, s42, 40960
    s_add_u32 s58, s58, 81920
    v_add_u32 v8, s58, v3
    s_mov_b32 s62, 0x200000
    v_mov_b32 v13, s58
    ds_read_b32 v14, v13
    v_mfma_f32_16x16x32_bf16 v[52:55], v[116:119], v[196:199], v[52:55]
    v_mfma_f32_16x16x32_bf16 v[56:59], v[120:123], v[196:199], v[56:59]
    v_mfma_f32_16x16x32_bf16 v[60:63], v[124:127], v[196:199], v[60:63]
    v_mfma_f32_16x16x32_bf16 v[64:67], v[128:131], v[196:199], v[64:67]
    v_mfma_f32_16x16x32_bf16 v[68:71], v[132:135], v[196:199], v[68:71]
    ds_read_b128 v[96:99], v208 offset:40960
    ds_read_b128 v[100:103], v208 offset:41984
    ds_read_b128 v[104:107], v208 offset:43008
    ds_read_b128 v[108:111], v208 offset:44032
    ds_read_b128 v[112:115], v208 offset:45056
    s_waitcnt lgkmcnt(10)
    v_mfma_f32_16x16x32_bf16 v[32:35], v[136:139], v[200:203], v[32:35]
    v_mfma_f32_16x16x32_bf16 v[36:39], v[140:143], v[200:203], v[36:39]
    v_mfma_f32_16x16x32_bf16 v[40:43], v[144:147], v[200:203], v[40:43]
    v_mfma_f32_16x16x32_bf16 v[44:47], v[148:151], v[200:203], v[44:47]
    v_mfma_f32_16x16x32_bf16 v[48:51], v[152:155], v[200:203], v[48:51]
    v_mfma_f32_16x16x32_bf16 v[52:55], v[136:139], v[204:207], v[52:55]
    v_mfma_f32_16x16x32_bf16 v[56:59], v[140:143], v[204:207], v[56:59]
    v_mfma_f32_16x16x32_bf16 v[60:63], v[144:147], v[204:207], v[60:63]
    v_mfma_f32_16x16x32_bf16 v[64:67], v[148:151], v[204:207], v[64:67]
    v_mfma_f32_16x16x32_bf16 v[68:71], v[152:155], v[204:207], v[68:71]
    s_waitcnt vmcnt(0)
    v_cmp_eq_u32 vcc, -1, v12
    s_nop 3
    s_cmp_lg_u64 vcc, 0
    s_cbranch_scc1 L_p5_lw
    buffer_load_dwordx4 v[16:19], v3, s[16:19], s54 offen offset:0 sc1
    buffer_load_dwordx4 v[20:23], v3, s[16:19], s55 offen offset:0 sc1
    buffer_load_dwordx4 v[80:83], v3, s[16:19], s54 offen offset:3072 sc1
    buffer_load_dwordx4 v[84:87], v3, s[16:19], s55 offen offset:3072 sc1
    buffer_load_dwordx2 v[88:89], v213, s[16:19], s54 offen offset:0 sc1
    buffer_load_dwordx2 v[90:91], v213, s[16:19], s54 offen offset:128 sc1
    buffer_load_dwordx4 v[24:27], v3, s[16:19], s54 offen offset:1024 sc1
    s_waitcnt lgkmcnt(0)
    s_barrier
    ds_read_b128 v[116:119], v208 offset:0
    ds_read_b128 v[120:123], v208 offset:1024
    ds_read_b128 v[124:127], v208 offset:2048
    ds_read_b128 v[128:131], v208 offset:3072
    ds_read_b128 v[132:135], v208 offset:4096
    ds_read_b128 v[136:139], v209 offset:4096
    ds_read_b128 v[140:143], v209 offset:5120
    ds_read_b128 v[144:147], v209 offset:6144
    ds_read_b128 v[148:151], v209 offset:7168
    ds_read_b128 v[152:155], v209 offset:8192
    s_branch L_p5_go
L_p5_lw:
    buffer_load_dword v12, v212, s[16:19], 0 offen sc0 sc1
    s_waitcnt lgkmcnt(0)
    s_barrier
    s_branch L_p5_be
L_p5_bh:
    s_mul_i32 s56, s41, 5120
    s_add_u32 s59, s56, s73
    s_mov_b32 m0, s56
    s_add_u32 s59, s59, 20480
    s_barrier
    ds_read_b32 v10, v9
    buffer_load_dwordx4 v3, s[16:19], s59 offen offset:0 sc1 lds
    buffer_load_dwordx4 v3, s[16:19], s59 offen offset:1024 sc1 lds
    buffer_load_dwordx4 v3, s[16:19], s59 offen offset:2048 sc1 lds
    buffer_load_dwordx4 v3, s[16:19], s59 offen offset:3072 sc1 lds
    s_add_u32 m0, s56, 4096
    s_add_u32 s59, s59, 4096
    buffer_load_dwordx4 v3, s[16:19], s59 offen offset:0 sc1 lds
    s_add_u32 m0, s56, 61440
    s_add_u32 s59, s59, 16384
    buffer_load_dwordx4 v3, s[16:19], s59 offen offset:0 sc1 lds
    buffer_load_dwordx4 v3, s[16:19], s59 offen offset:1024 sc1 lds
    buffer_load_dwordx4 v3, s[16:19], s59 offen offset:2048 sc1 lds
    buffer_load_dwordx4 v3, s[16:19], s59 offen offset:3072 sc1 lds
    s_add_u32 m0, s56, 65536
    s_add_u32 s59, s59, 4096
    buffer_load_dwordx4 v3, s[16:19], s59 offen offset:0 sc1 lds
    s_waitcnt lgkmcnt(0)
    v_cmp_ne_u32 vcc, v10, v11
    s_nop 3
    s_cmp_lg_u64 vcc, 0
    s_cbranch_scc1 L_at_redo
    ds_read_b128 v[96:99], v209 offset:45056
    ds_read_b128 v[100:103], v209 offset:46080
    ds_read_b128 v[104:107], v209 offset:47104
    ds_read_b128 v[108:111], v209 offset:48128
    ds_read_b128 v[112:115], v209 offset:49152
    ds_read_b128 v[116:119], v210 offset:8192
    ds_read_b128 v[120:123], v210 offset:9216
    ds_read_b128 v[124:127], v210 offset:10240
    ds_read_b128 v[128:131], v210 offset:11264
    ds_read_b128 v[132:135], v210 offset:12288
    ds_read_b128 v[136:139], v210 offset:28672
    ds_read_b128 v[140:143], v210 offset:29696
    ds_read_b128 v[144:147], v210 offset:30720
    ds_read_b128 v[148:151], v210 offset:31744
    ds_read_b128 v[152:155], v210 offset:32768
    s_mul_i32 s54, s76, 20480
    s_lshl_b32 s55, s6, 12
    s_add_u32 s54, s54, s55
    s_add_u32 s54, s54, 10813440
    s_add_u32 s55, s54, 20480
    s_mul_i32 s58, s42, 40960
    s_add_u32 s58, s58, 81920
    v_add_u32 v8, s58, v3
    s_mov_b32 s62, 0x200000
    v_mov_b32 v13, s58
    ds_read_b32 v14, v13
    v_mfma_f32_16x16x32_bf16 v[32:35], v[216:219], v[168:171], 0
    v_mfma_f32_16x16x32_bf16 v[36:39], v[220:223], v[168:171], 0
    v_mfma_f32_16x16x32_bf16 v[40:43], v[224:227], v[168:171], 0
    v_mfma_f32_16x16x32_bf16 v[44:47], v[228:231], v[168:171], 0
    v_mfma_f32_16x16x32_bf16 v[48:51], v[232:235], v[168:171], 0
    v_mfma_f32_16x16x32_bf16 v[52:55], v[216:219], v[172:175], 0
    v_mfma_f32_16x16x32_bf16 v[56:59], v[220:223], v[172:175], 0
    v_mfma_f32_16x16x32_bf16 v[60:63], v[224:227], v[172:175], 0
    v_mfma_f32_16x16x32_bf16 v[64:67], v[228:231], v[172:175], 0
    v_mfma_f32_16x16x32_bf16 v[68:71], v[232:235], v[172:175], 0
    ds_read_b128 v[216:219], v209 offset:24576
    ds_read_b128 v[220:223], v209 offset:25600
    ds_read_b128 v[224:227], v209 offset:26624
    ds_read_b128 v[228:231], v209 offset:27648
    ds_read_b128 v[232:235], v209 offset:28672
    v_mfma_f32_16x16x32_bf16 v[32:35], v[236:239], v[176:179], v[32:35]
    v_mfma_f32_16x16x32_bf16 v[36:39], v[240:243], v[176:179], v[36:39]
    v_mfma_f32_16x16x32_bf16 v[40:43], v[244:247], v[176:179], v[40:43]
    v_mfma_f32_16x16x32_bf16 v[44:47], v[248:251], v[176:179], v[44:47]
    v_mfma_f32_16x16x32_bf16 v[48:51], v[252:255], v[176:179], v[48:51]
    buffer_load_dword v12, v212, s[16:19], 0 offen sc0 sc1
    v_mfma_f32_16x16x32_bf16 v[52:55], v[236:239], v[180:183], v[52:55]
    v_mfma_f32_16x16x32_bf16 v[56:59], v[240:243], v[180:183], v[56:59]
    v_mfma_f32_16x16x32_bf16 v[60:63], v[244:247], v[180:183], v[60:63]
    v_mfma_f32_16x16x32_bf16 v[64:67], v[248:251], v[180:183], v[64:67]
    v_mfma_f32_16x16x32_bf16 v[68:71], v[252:255], v[180:183], v[68:71]
    ds_read_b128 v[236:239], v208 offset:20480
    ds_read_b128 v[240:243], v208 offset:21504
    ds_read_b128 v[244:247], v208 offset:22528
    ds_read_b128 v[248:251], v208 offset:23552
    ds_read_b128 v[252:255], v208 offset:24576
    s_waitcnt lgkmcnt(10)
    v_mfma_f32_16x16x32_bf16 v[32:35], v[96:99], v[184:187], v[32:35]
    v_mfma_f32_16x16x32_bf16 v[36:39], v[100:103], v[184:187], v[36:39]
    v_mfma_f32_16x16x32_bf16 v[40:43], v[104:107], v[184:187], v[40:43]
    v_mfma_f32_16x16x32_bf16 v[44:47], v[108:111], v[184:187], v[44:47]
    v_mfma_f32_16x16x32_bf16 v[48:51], v[112:115], v[184:187], v[48:51]
    v_mfma_f32_16x16x32_bf16 v[52:55], v[96:99], v[188:191], v[52:55]
    v_mfma_f32_16x16x32_bf16 v[56:59], v[100:103], v[188:191], v[56:59]
    v_mfma_f32_16x16x32_bf16 v[60:63], v[104:107], v[188:191], v[60:63]
    v_mfma_f32_16x16x32_bf16 v[64:67], v[108:111], v[188:191], v[64:67]
    v_mfma_f32_16x16x32_bf16 v[68:71], v[112:115], v[188:191], v[68:71]
    ds_read_b128 v[96:99], v208 offset:40960
    ds_read_b128 v[100:103], v208 offset:41984
    ds_read_b128 v[104:107], v208 offset:43008
    ds_read_b128 v[108:111], v208 offset:44032
    ds_read_b128 v[112:115], v208 offset:45056
    s_waitcnt lgkmcnt(10)
    v_mfma_f32_16x16x32_bf16 v[32:35], v[116:119], v[192:195], v[32:35]
    v_mfma_f32_16x16x32_bf16 v[36:39], v[120:123], v[192:195], v[36:39]
    v_mfma_f32_16x16x32_bf16 v[40:43], v[124:127], v[192:195], v[40:43]
    v_mfma_f32_16x16x32_bf16 v[44:47], v[128:131], v[192:195], v[44:47]
    v_mfma_f32_16x16x32_bf16 v[48:51], v[132:135], v[192:195], v[48:51]
    v_mfma_f32_16x16x32_bf16 v[52:55], v[116:119], v[196:199], v[52:55]
    v_mfma_f32_16x16x32_bf16 v[56:59], v[120:123], v[196:199], v[56:59]
    v_mfma_f32_16x16x32_bf16 v[60:63], v[124:127], v[196:199], v[60:63]
    v_mfma_f32_16x16x32_bf16 v[64:67], v[128:131], v[196:199], v[64:67]
    v_mfma_f32_16x16x32_bf16 v[68:71], v[132:135], v[196:199], v[68:71]
    s_waitcnt vmcnt(1) lgkmcnt(0)
    s_barrier
    v_mfma_f32_16x16x32_bf16 v[32:35], v[136:139], v[200:203], v[32:35]
    v_mfma_f32_16x16x32_bf16 v[36:39], v[140:143], v[200:203], v[36:39]
    v_mfma_f32_16x16x32_bf16 v[40:43], v[144:147], v[200:203], v[40:43]
    v_mfma_f32_16x16x32_bf16 v[44:47], v[148:151], v[200:203], v[44:47]
    v_mfma_f32_16x16x32_bf16 v[48:51], v[152:155], v[200:203], v[48:51]
    v_mfma_f32_16x16x32_bf16 v[52:55], v[136:139], v[204:207], v[52:55]
    v_mfma_f32_16x16x32_bf16 v[56:59], v[140:143], v[204:207], v[56:59]
    v_mfma_f32_16x16x32_bf16 v[60:63], v[144:147], v[204:207], v[60:63]
    v_mfma_f32_16x16x32_bf16 v[64:67], v[148:151], v[204:207], v[64:67]
    v_mfma_f32_16x16x32_bf16 v[68:71], v[152:155], v[204:207], v[68:71]
    s_waitcnt vmcnt(0)
    v_cmp_eq_u32 vcc, -1, v12
    s_nop 3
    s_cmp_lg_u64 vcc, 0
    s_cbranch_scc1 L_p5_hw
    buffer_load_dwordx4 v[16:19], v3, s[16:19], s54 offen offset:0 sc1
    buffer_load_dwordx4 v[20:23], v3, s[16:19], s55 offen offset:0 sc1
    buffer_load_dwordx4 v[80:83], v3, s[16:19], s54 offen offset:3072 sc1
    buffer_load_dwordx4 v[84:87], v3, s[16:19], s55 offen offset:3072 sc1
    buffer_load_dwordx2 v[88:89], v213, s[16:19], s54 offen offset:0 sc1
    buffer_load_dwordx2 v[90:91], v213, s[16:19], s54 offen offset:128 sc1
    buffer_load_dwordx4 v[24:27], v3, s[16:19], s54 offen offset:1024 sc1
    ds_read_b128 v[116:119], v208 offset:0
    ds_read_b128 v[120:123], v208 offset:1024
    ds_read_b128 v[124:127], v208 offset:2048
    ds_read_b128 v[128:131], v208 offset:3072
    ds_read_b128 v[132:135], v208 offset:4096
    ds_read_b128 v[136:139], v209 offset:4096
    ds_read_b128 v[140:143], v209 offset:5120
    ds_read_b128 v[144:147], v209 offset:6144
    ds_read_b128 v[148:151], v209 offset:7168
    ds_read_b128 v[152:155], v209 offset:8192
    s_branch L_p5_go
L_p5_hw:
    buffer_load_dword v12, v212, s[16:19], 0 offen sc0 sc1
L_p5_be:
    ds_read_b128 v[116:119], v208 offset:0
    ds_read_b128 v[120:123], v208 offset:1024
    ds_read_b128 v[124:127], v208 offset:2048
    ds_read_b128 v[128:131], v208 offset:3072
    ds_read_b128 v[132:135], v208 offset:4096
    ds_read_b128 v[136:139], v209 offset:4096
    ds_read_b128 v[140:143], v209 offset:5120
    ds_read_b128 v[144:147], v209 offset:6144
    ds_read_b128 v[148:151], v209 offset:7168
    ds_read_b128 v[152:155], v209 offset:8192
    s_branch L_p5_pt
L_p5_poll:
    s_sub_u32 s62, s62, 1
    s_cbranch_scc1 L_p5_ld
    buffer_load_dword v12, v212, s[16:19], 0 offen sc0 sc1
L_p5_pt:
    s_waitcnt vmcnt(0)
    v_cmp_eq_u32 vcc, -1, v12
    s_nop 3
    s_cmp_eq_u64 vcc, 0
    s_cbranch_scc1 L_p5_ld
    s_sleep 1
    s_branch L_p5_poll
L_p5_ld:
    buffer_load_dwordx4 v[16:19], v3, s[16:19], s54 offen offset:0 sc1
    buffer_load_dwordx4 v[20:23], v3, s[16:19], s55 offen offset:0 sc1
    buffer_load_dwordx4 v[80:83], v3, s[16:19], s54 offen offset:3072 sc1
    buffer_load_dwordx4 v[84:87], v3, s[16:19], s55 offen offset:3072 sc1
    buffer_load_dwordx2 v[88:89], v213, s[16:19], s54 offen offset:0 sc1
    buffer_load_dwordx2 v[90:91], v213, s[16:19], s54 offen offset:128 sc1
    buffer_load_dwordx4 v[24:27], v3, s[16:19], s54 offen offset:1024 sc1
L_p5_go:
    v_mov_b32 v10, 0
    s_waitcnt vmcnt(6) lgkmcnt(10)
    v_max3_u32 v10, v16, v17, v10
    v_max3_u32 v10, v18, v19, v10
    v_mfma_f32_16x16x32_bf16 v[168:171], v[216:219], v[16:19], v[32:35]
    v_mfma_f32_16x16x32_bf16 v[172:175], v[220:223], v[16:19], v[36:39]
    v_mfma_f32_16x16x32_bf16 v[176:179], v[224:227], v[16:19], v[40:43]
    v_mfma_f32_16x16x32_bf16 v[180:183], v[228:231], v[16:19], v[44:47]
    v_mfma_f32_16x16x32_bf16 v[184:187], v[232:235], v[16:19], v[48:51]
    buffer_load_dwordx4 v[72:75], v3, s[16:19], s54 offen offset:2048 sc1
    s_waitcnt vmcnt(6)
    v_max3_u32 v10, v20, v21, v10
    v_max3_u32 v10, v22, v23, v10
    v_mfma_f32_16x16x32_bf16 v[188:191], v[216:219], v[20:23], v[52:55]
    v_mfma_f32_16x16x32_bf16 v[192:195], v[220:223], v[20:23], v[56:59]
    v_mfma_f32_16x16x32_bf16 v[196:199], v[224:227], v[20:23], v[60:63]
    v_mfma_f32_16x16x32_bf16 v[200:203], v[228:231], v[20:23], v[64:67]
    v_mfma_f32_16x16x32_bf16 v[204:207], v[232:235], v[20:23], v[68:71]
    buffer_load_dwordx2 v[92:93], v213, s[16:19], s55 offen offset:0 sc1
    buffer_load_dwordx2 v[94:95], v213, s[16:19], s55 offen offset:128 sc1
    s_waitcnt vmcnt(7)
    v_max3_u32 v10, v80, v81, v10
    v_max3_u32 v10, v82, v83, v10
    v_mfma_f32_16x16x32_bf16 v[168:171], v[236:239], v[80:83], v[168:171]
    v_mfma_f32_16x16x32_bf16 v[172:175], v[240:243], v[80:83], v[172:175]
    v_mfma_f32_16x16x32_bf16 v[176:179], v[244:247], v[80:83], v[176:179]
    v_mfma_f32_16x16x32_bf16 v[180:183], v[248:251], v[80:83], v[180:183]
    v_mfma_f32_16x16x32_bf16 v[184:187], v[252:255], v[80:83], v[184:187]
    buffer_load_dwordx4 v[28:31], v3, s[16:19], s55 offen offset:1024 sc1
    s_waitcnt vmcnt(7)
    v_max3_u32 v10, v84, v85, v10
    v_max3_u32 v10, v86, v87, v10
    v_mfma_f32_16x16x32_bf16 v[188:191], v[236:239], v[84:87], v[188:191]
    v_mfma_f32_16x16x32_bf16 v[192:195], v[240:243], v[84:87], v[192:195]
    v_mfma_f32_16x16x32_bf16 v[196:199], v[244:247], v[84:87], v[196:199]
    v_mfma_f32_16x16x32_bf16 v[200:203], v[248:251], v[84:87], v[200:203]
    v_mfma_f32_16x16x32_bf16 v[204:207], v[252:255], v[84:87], v[204:207]
    buffer_load_dwordx4 v[76:79], v3, s[16:19], s55 offen offset:2048 sc1
    s_waitcnt vmcnt(6)
    v_max3_u32 v10, v88, v89, v10
    v_max3_u32 v10, v90, v91, v10
    v_mfma_f32_16x16x32_bf16 v[168:171], v[96:99], v[88:91], v[168:171]
    v_mfma_f32_16x16x32_bf16 v[172:175], v[100:103], v[88:91], v[172:175]
    v_mfma_f32_16x16x32_bf16 v[176:179], v[104:107], v[88:91], v[176:179]
    v_mfma_f32_16x16x32_bf16 v[180:183], v[108:111], v[88:91], v[180:183]
    v_mfma_f32_16x16x32_bf16 v[184:187], v[112:115], v[88:91], v[184:187]
    s_waitcnt vmcnt(5) lgkmcnt(0)
    v_max3_u32 v10, v24, v25, v10
    v_max3_u32 v10, v26, v27, v10
    v_mfma_f32_16x16x32_bf16 v[168:171], v[116:119], v[24:27], v[168:171]
    v_mfma_f32_16x16x32_bf16 v[172:175], v[120:123], v[24:27], v[172:175]
    v_mfma_f32_16x16x32_bf16 v[176:179], v[124:127], v[24:27], v[176:179]
    v_mfma_f32_16x16x32_bf16 v[180:183], v[128:131], v[24:27], v[180:183]
    v_mfma_f32_16x16x32_bf16 v[184:187], v[132:135], v[24:27], v[184:187]
    s_waitcnt vmcnt(4)
    v_max3_u32 v10, v72, v73, v10
    v_max3_u32 v10, v74, v75, v10
    v_mfma_f32_16x16x32_bf16 v[168:171], v[136:139], v[72:75], v[168:171]
    v_mfma_f32_16x16x32_bf16 v[172:175], v[140:143], v[72:75], v[172:175]
    v_mfma_f32_16x16x32_bf16 v[176:179], v[144:147], v[72:75], v[176:179]
    v_mfma_f32_16x16x32_bf16 v[180:183], v[148:151], v[72:75], v[180:183]
    v_mfma_f32_16x16x32_bf16 v[184:187], v[152:155], v[72:75], v[184:187]
    s_waitcnt vmcnt(2)
    v_max3_u32 v10, v92, v93, v10
    v_max3_u32 v10, v94, v95, v10
    v_mfma_f32_16x16x32_bf16 v[188:191], v[96:99], v[92:95], v[188:191]
    v_mfma_f32_16x16x32_bf16 v[192:195], v[100:103], v[92:95], v[192:195]
    v_mfma_f32_16x16x32_bf16 v[196:199], v[104:107], v[92:95], v[196:199]
    v_mfma_f32_16x16x32_bf16 v[200:203], v[108:111], v[92:95], v[200:203]
    v_mfma_f32_16x16x32_bf16 v[204:207], v[112:115], v[92:95], v[204:207]
    s_mul_i32 s58, s6, 10240
    v_add_u32 v9, s58, v8
    s_cmp_eq_u32 s6, 0
    s_cbranch_scc1 L_ze_117
    ds_write_b128 v9, v[168:171] offset:0
    ds_write_b128 v9, v[172:175] offset:1024
    ds_write_b128 v9, v[184:187] offset:4096
L_ze_117:
    s_cmp_eq_u32 s6, 1
    s_cbranch_scc1 L_ze_118
    ds_write_b128 v9, v[176:179] offset:2048
    ds_write_b128 v9, v[180:183] offset:3072
L_ze_118:
    s_waitcnt vmcnt(1)
    v_max3_u32 v10, v28, v29, v10
    v_max3_u32 v10, v30, v31, v10
    v_mfma_f32_16x16x32_bf16 v[188:191], v[116:119], v[28:31], v[188:191]
    v_mfma_f32_16x16x32_bf16 v[192:195], v[120:123], v[28:31], v[192:195]
    v_mfma_f32_16x16x32_bf16 v[196:199], v[124:127], v[28:31], v[196:199]
    v_mfma_f32_16x16x32_bf16 v[200:203], v[128:131], v[28:31], v[200:203]
    v_mfma_f32_16x16x32_bf16 v[204:207], v[132:135], v[28:31], v[204:207]
    s_waitcnt vmcnt(0)
    v_max3_u32 v10, v76, v77, v10
    v_max3_u32 v10, v78, v79, v10
    v_cmp_eq_u32 vcc, -1, v10
    v_mfma_f32_16x16x32_bf16 v[188:191], v[136:139], v[76:79], v[188:191]
    v_mfma_f32_16x16x32_bf16 v[192:195], v[140:143], v[76:79], v[192:195]
    v_mfma_f32_16x16x32_bf16 v[196:199], v[144:147], v[76:79], v[196:199]
    v_mfma_f32_16x16x32_bf16 v[200:203], v[148:151], v[76:79], v[200:203]
    v_mfma_f32_16x16x32_bf16 v[204:207], v[152:155], v[76:79], v[204:207]
    s_cmp_eq_u64 vcc, 0
    s_cbranch_scc1 L_p5_ok

    s_sub_u32 s62, s62, 1
    s_cmp_lt_i32 s62, 0
    s_cbranch_scc0 L_p5_ld
L_p5_ok:
    s_cmp_lg_u32 s6, 0
    s_cbranch_scc1 L_p5_f1
    s_nop 4
    ds_write_b128 v8, v[188:191] offset:5120
    ds_write_b128 v8, v[192:195] offset:6144
    ds_write_b128 v8, v[196:199] offset:7168
    ds_write_b128 v8, v[200:203] offset:8192
    ds_write_b128 v8, v[204:207] offset:9216
    v_mov_b32 v15, 1
    v_readfirstlane_b32 s58, v14
    s_mov_b64 exec, 1
    s_mov_b32 s62, 0x4000000
    ds_add_rtn_u32 v14, v13, v15
    s_add_u32 s58, s58, 3
    s_waitcnt lgkmcnt(0)
    v_readfirstlane_b32 s59, v14
    s_cmp_eq_u32 s59, s58
    s_cbranch_scc1 L_p5_g0
    s_add_u32 s58, s58, 1
L_p5_s0:
    ds_read_b32 v14, v13
    s_waitcnt lgkmcnt(0)
    v_readfirstlane_b32 s59, v14
    s_cmp_eq_u32 s59, s58
    s_cbranch_scc1 L_p5_g0
    s_sleep 1
    s_sub_u32 s62, s62, 1
    s_cbranch_scc0 L_p5_s0
L_p5_g0:
    s_mov_b64 exec, -1
    ds_read_b128 v[96:99], v8 offset:10240
    ds_read_b128 v[100:103], v8 offset:11264
    ds_read_b128 v[104:107], v8 offset:14336
    ds_read_b128 v[108:111], v8 offset:20480
    ds_read_b128 v[112:115], v8 offset:21504
    ds_read_b128 v[116:119], v8 offset:24576
    ds_read_b128 v[120:123], v8 offset:30720
    ds_read_b128 v[124:127], v8 offset:31744
    ds_read_b128 v[128:131], v8 offset:34816
    s_waitcnt lgkmcnt(6)
    v_pk_add_f32 v[168:169], v[168:169], v[96:97]
    v_pk_add_f32 v[170:171], v[170:171], v[98:99]
    v_pk_add_f32 v[172:173], v[172:173], v[100:101]
    v_pk_add_f32 v[174:175], v[174:175], v[102:103]
    v_pk_add_f32 v[184:185], v[184:185], v[104:105]
    v_pk_add_f32 v[186:187], v[186:187], v[106:107]
    s_waitcnt lgkmcnt(3)
    v_pk_add_f32 v[168:169], v[168:169], v[108:109]
    v_pk_add_f32 v[170:171], v[170:171], v[110:111]
    v_pk_add_f32 v[172:173], v[172:173], v[112:113]
    v_pk_add_f32 v[174:175], v[174:175], v[114:115]
    v_pk_add_f32 v[184:185], v[184:185], v[116:117]
    v_pk_add_f32 v[186:187], v[186:187], v[118:119]
    s_waitcnt lgkmcnt(0)
    v_pk_add_f32 v[168:169], v[168:169], v[120:121]
    v_pk_add_f32 v[170:171], v[170:171], v[122:123]
    v_pk_add_f32 v[172:173], v[172:173], v[124:125]
    v_pk_add_f32 v[174:175], v[174:175], v[126:127]
    v_pk_add_f32 v[184:185], v[184:185], v[128:129]
    v_pk_add_f32 v[186:187], v[186:187], v[130:131]
    v_cvt_pk_bf16_f32 v16, v168, v169
    v_cvt_pk_bf16_f32 v17, v170, v171
    v_cvt_pk_bf16_f32 v18, v172, v173
    v_cvt_pk_bf16_f32 v19, v174, v175
    v_cvt_pk_bf16_f32 v20, v184, v185
    v_cvt_pk_bf16_f32 v21, v186, v187
    buffer_store_dwordx4 v[16:19], v214, s[24:27], 0 offen offset:0 sc1
    v_mov_b64 v[22:23], v[20:21]
    s_nop 1
    v_permlane16_swap_b32 v20, v22
    v_permlane16_swap_b32 v21, v23
    s_mov_b32 exec_lo, 0xffff
    s_mov_b32 exec_hi, 0xffff
    buffer_store_dwordx4 v[20:23], v215, s[24:27], 0 offen offset:128 sc1
    s_mov_b64 exec, -1
    s_branch L_p5_end
L_p5_f1:
    s_cmp_lg_u32 s6, 1
    s_cbranch_scc1 L_p5_f2
    s_nop 4
    ds_write_b128 v8, v[188:191] offset:15360
    ds_write_b128 v8, v[192:195] offset:16384
    ds_write_b128 v8, v[196:199] offset:17408
    ds_write_b128 v8, v[200:203] offset:18432
    ds_write_b128 v8, v[204:207] offset:19456
    v_mov_b32 v15, 1
    v_readfirstlane_b32 s58, v14
    s_mov_b64 exec, 1
    s_mov_b32 s62, 0x4000000
    ds_add_rtn_u32 v14, v13, v15
    s_add_u32 s58, s58, 3
    s_waitcnt lgkmcnt(0)
    v_readfirstlane_b32 s59, v14
    s_cmp_eq_u32 s59, s58
    s_cbranch_scc1 L_p5_g1
    s_add_u32 s58, s58, 1
L_p5_s1:
    ds_read_b32 v14, v13
    s_waitcnt lgkmcnt(0)
    v_readfirstlane_b32 s59, v14
    s_cmp_eq_u32 s59, s58
    s_cbranch_scc1 L_p5_g1
    s_sleep 1
    s_sub_u32 s62, s62, 1
    s_cbranch_scc0 L_p5_s1
L_p5_g1:
    s_mov_b64 exec, -1
    ds_read_b128 v[96:99], v8 offset:2048
    ds_read_b128 v[100:103], v8 offset:3072
    ds_read_b128 v[108:111], v8 offset:22528
    ds_read_b128 v[112:115], v8 offset:23552
    ds_read_b128 v[120:123], v8 offset:32768
    ds_read_b128 v[124:127], v8 offset:33792
    s_waitcnt lgkmcnt(4)
    v_pk_add_f32 v[176:177], v[176:177], v[96:97]
    v_pk_add_f32 v[178:179], v[178:179], v[98:99]
    v_pk_add_f32 v[180:181], v[180:181], v[100:101]
    v_pk_add_f32 v[182:183], v[182:183], v[102:103]
    s_waitcnt lgkmcnt(2)
    v_pk_add_f32 v[176:177], v[176:177], v[108:109]
    v_pk_add_f32 v[178:179], v[178:179], v[110:111]
    v_pk_add_f32 v[180:181], v[180:181], v[112:113]
    v_pk_add_f32 v[182:183], v[182:183], v[114:115]
    s_waitcnt lgkmcnt(0)
    v_pk_add_f32 v[176:177], v[176:177], v[120:121]
    v_pk_add_f32 v[178:179], v[178:179], v[122:123]
    v_pk_add_f32 v[180:181], v[180:181], v[124:125]
    v_pk_add_f32 v[182:183], v[182:183], v[126:127]
    v_cvt_pk_bf16_f32 v16, v176, v177
    v_cvt_pk_bf16_f32 v17, v178, v179
    v_cvt_pk_bf16_f32 v18, v180, v181
    v_cvt_pk_bf16_f32 v19, v182, v183
    buffer_store_dwordx4 v[16:19], v214, s[24:27], 0 offen offset:64 sc1
    s_branch L_p5_end
L_p5_f2:
    s_cmp_lg_u32 s6, 2
    s_cbranch_scc1 L_p5_f3
    s_nop 4
    ds_write_b128 v8, v[196:199] offset:27648
    ds_write_b128 v8, v[200:203] offset:28672
    v_mov_b32 v15, 1
    v_readfirstlane_b32 s58, v14
    s_mov_b64 exec, 1
    s_mov_b32 s62, 0x4000000
    ds_add_rtn_u32 v14, v13, v15
    s_add_u32 s58, s58, 3
    s_waitcnt lgkmcnt(0)
    v_readfirstlane_b32 s59, v14
    s_cmp_eq_u32 s59, s58
    s_cbranch_scc1 L_p5_g2
    s_add_u32 s58, s58, 1
L_p5_s2:
    ds_read_b32 v14, v13
    s_waitcnt lgkmcnt(0)
    v_readfirstlane_b32 s59, v14
    s_cmp_eq_u32 s59, s58
    s_cbranch_scc1 L_p5_g2
    s_sleep 1
    s_sub_u32 s62, s62, 1
    s_cbranch_scc0 L_p5_s2
L_p5_g2:
    s_mov_b64 exec, -1
    ds_read_b128 v[96:99], v8 offset:5120
    ds_read_b128 v[100:103], v8 offset:6144
    ds_read_b128 v[104:107], v8 offset:9216
    ds_read_b128 v[108:111], v8 offset:15360
    ds_read_b128 v[112:115], v8 offset:16384
    ds_read_b128 v[116:119], v8 offset:19456
    ds_read_b128 v[120:123], v8 offset:35840
    ds_read_b128 v[124:127], v8 offset:36864
    ds_read_b128 v[128:131], v8 offset:39936
    s_waitcnt lgkmcnt(6)
    v_pk_add_f32 v[188:189], v[188:189], v[96:97]
    v_pk_add_f32 v[190:191], v[190:191], v[98:99]
    v_pk_add_f32 v[192:193], v[192:193], v[100:101]
    v_pk_add_f32 v[194:195], v[194:195], v[102:103]
    v_pk_add_f32 v[204:205], v[204:205], v[104:105]
    v_pk_add_f32 v[206:207], v[206:207], v[106:107]
    s_waitcnt lgkmcnt(3)
    v_pk_add_f32 v[188:189], v[188:189], v[108:109]
    v_pk_add_f32 v[190:191], v[190:191], v[110:111]
    v_pk_add_f32 v[192:193], v[192:193], v[112:113]
    v_pk_add_f32 v[194:195], v[194:195], v[114:115]
    v_pk_add_f32 v[204:205], v[204:205], v[116:117]
    v_pk_add_f32 v[206:207], v[206:207], v[118:119]
    s_waitcnt lgkmcnt(0)
    v_pk_add_f32 v[188:189], v[188:189], v[120:121]
    v_pk_add_f32 v[190:191], v[190:191], v[122:123]
    v_pk_add_f32 v[192:193], v[192:193], v[124:125]
    v_pk_add_f32 v[194:195], v[194:195], v[126:127]
    v_pk_add_f32 v[204:205], v[204:205], v[128:129]
    v_pk_add_f32 v[206:207], v[206:207], v[130:131]
    v_cvt_pk_bf16_f32 v16, v188, v189
    v_cvt_pk_bf16_f32 v17, v190, v191
    v_cvt_pk_bf16_f32 v18, v192, v193
    v_cvt_pk_bf16_f32 v19, v194, v195
    v_cvt_pk_bf16_f32 v20, v204, v205
    v_cvt_pk_bf16_f32 v21, v206, v207
    buffer_store_dwordx4 v[16:19], v214, s[24:27], 0 offen offset:0 sc1
    v_mov_b64 v[22:23], v[20:21]
    s_nop 1
    v_permlane16_swap_b32 v20, v22
    v_permlane16_swap_b32 v21, v23
    s_mov_b32 exec_lo, 0xffff
    s_mov_b32 exec_hi, 0xffff
    buffer_store_dwordx4 v[20:23], v215, s[24:27], 0 offen offset:128 sc1
    s_mov_b64 exec, -1
    s_branch L_p5_end
L_p5_f3:
    s_nop 4
    ds_write_b128 v8, v[188:191] offset:35840
    ds_write_b128 v8, v[192:195] offset:36864
    ds_write_b128 v8, v[204:207] offset:39936
    v_mov_b32 v15, 1
    v_readfirstlane_b32 s58, v14
    s_mov_b64 exec, 1
    s_mov_b32 s62, 0x4000000
    ds_add_rtn_u32 v14, v13, v15
    s_add_u32 s58, s58, 3
    s_waitcnt lgkmcnt(0)
    v_readfirstlane_b32 s59, v14
    s_cmp_eq_u32 s59, s58
    s_cbranch_scc1 L_p5_g3
    s_add_u32 s58, s58, 1
L_p5_s3:
    ds_read_b32 v14, v13
    s_waitcnt lgkmcnt(0)
    v_readfirstlane_b32 s59, v14
    s_cmp_eq_u32 s59, s58
    s_cbranch_scc1 L_p5_g3
    s_sleep 1
    s_sub_u32 s62, s62, 1
    s_cbranch_scc0 L_p5_s3
L_p5_g3:
    s_mov_b64 exec, -1
    ds_read_b128 v[96:99], v8 offset:7168
    ds_read_b128 v[100:103], v8 offset:8192
    ds_read_b128 v[108:111], v8 offset:17408
    ds_read_b128 v[112:115], v8 offset:18432
    ds_read_b128 v[120:123], v8 offset:27648
    ds_read_b128 v[124:127], v8 offset:28672
    s_waitcnt lgkmcnt(4)
    v_pk_add_f32 v[196:197], v[196:197], v[96:97]
    v_pk_add_f32 v[198:199], v[198:199], v[98:99]
    v_pk_add_f32 v[200:201], v[200:201], v[100:101]
    v_pk_add_f32 v[202:203], v[202:203], v[102:103]
    s_waitcnt lgkmcnt(2)
    v_pk_add_f32 v[196:197], v[196:197], v[108:109]
    v_pk_add_f32 v[198:199], v[198:199], v[110:111]
    v_pk_add_f32 v[200:201], v[200:201], v[112:113]
    v_pk_add_f32 v[202:203], v[202:203], v[114:115]
    s_waitcnt lgkmcnt(0)
    v_pk_add_f32 v[196:197], v[196:197], v[120:121]
    v_pk_add_f32 v[198:199], v[198:199], v[122:123]
    v_pk_add_f32 v[200:201], v[200:201], v[124:125]
    v_pk_add_f32 v[202:203], v[202:203], v[126:127]
    v_cvt_pk_bf16_f32 v16, v196, v197
    v_cvt_pk_bf16_f32 v17, v198, v199
    v_cvt_pk_bf16_f32 v18, v200, v201
    v_cvt_pk_bf16_f32 v19, v202, v203
    buffer_store_dwordx4 v[16:19], v214, s[24:27], 0 offen offset:64 sc1
L_p5_end:
    s_xor_b32 s60, s38, 4
    s_or_b32 s60, s2, s60
    s_cmp_lg_u32 s60, 0
    s_cbranch_scc1 L_nc_119
    v_mov_b32 v0, 0
    s_mov_b64 exec, 1
    buffer_store_dword v0, v0, s[20:23], 0 offen sc0 sc1
    s_mov_b64 exec, -1
L_nc_119:
    s_branch L_end1
L_at_redo:
    s_bitset1_b32 s68, 0
    s_waitcnt vmcnt(0) lgkmcnt(0)
    s_barrier
    s_mul_i32 s69, s42, 81920
    s_add_u32 s69, s69, s71
    buffer_load_dwordx4 v[124:127], v164, s[16:19], s71 offen sc1
    buffer_load_dword v132, v165, s[16:19], s71 offen offset:1024 sc1
    buffer_load_dwordx4 v[128:131], v164, s[16:19], s69 offen sc1
    buffer_load_dword v134, v165, s[16:19], s69 offen offset:1024 sc1
    s_add_u32 s69, s69, 1280
    s_add_u32 m0, s70, 0
    s_add_u32 s54, s69, 4096
    buffer_load_dwordx4 v163, s[16:19], s69 offen sc1 lds
    buffer_load_dwordx4 v163, s[16:19], s69 offen offset:1024 sc1 lds
    buffer_load_dwordx4 v163, s[16:19], s69 offen offset:2048 sc1 lds
    buffer_load_dwordx4 v163, s[16:19], s69 offen offset:3072 sc1 lds
    s_add_u32 m0, s70, 4096
    s_add_u32 s69, s69, 20480
    buffer_load_dwordx4 v163, s[16:19], s54 offen sc1 lds
    v_mov_b32 v133, 0x3f803f80
    v_mov_b32 v135, 0x3f803f80
    v_mov_b32 v121, 0
    v_mov_b32 v123, 0
    v_mov_b32 v166, 0xff800000
    v_mov_b32 v167, 0xff800000
    s_mov_b32 s56, s71
    s_mov_b32 s57, 64
L_at_max:
    s_waitcnt vmcnt(0)
    v_mfma_f32_32x32x16_bf16 v[16:31], v[124:127], v[112:115], 0
    v_mfma_f32_32x32x8_bf16 v[16:31], v[132:133], v[120:121], v[16:31]
    v_mfma_f32_32x32x16_bf16 v[32:47], v[124:127], v[116:119], 0
    v_mfma_f32_32x32x8_bf16 v[32:47], v[132:133], v[122:123], v[32:47]
    s_nop 7
    s_nop 5
    v_max3_f32 v166, v16, v17, v166
    v_max3_f32 v167, v32, v33, v167
    v_max3_f32 v166, v18, v19, v166
    v_max3_f32 v167, v34, v35, v167
    v_max3_f32 v166, v20, v21, v166
    v_max3_f32 v167, v36, v37, v167
    v_max3_f32 v166, v22, v23, v166
    v_max3_f32 v167, v38, v39, v167
    v_max3_f32 v166, v24, v25, v166
    v_max3_f32 v167, v40, v41, v167
    v_max3_f32 v166, v26, v27, v166
    v_max3_f32 v167, v42, v43, v167
    v_max3_f32 v166, v28, v29, v166
    v_max3_f32 v167, v44, v45, v167
    v_max3_f32 v166, v30, v31, v166
    v_max3_f32 v167, v46, v47, v167
    s_add_u32 s56, s56, 2560
    buffer_load_dwordx4 v[124:127], v164, s[16:19], s56 offen sc1
    buffer_load_dword v132, v165, s[16:19], s56 offen offset:1024 sc1
    s_sub_u32 s57, s57, 1
    s_cmp_lg_u32 s57, 0
    s_cbranch_scc1 L_at_max
    v_cmp_gt_u32 vcc, 32, v2
    v_mov_b32 v176, v166
    v_mov_b32 v179, v167
    s_nop 0
    v_permlane32_swap_b32 v176, v166
    v_permlane32_swap_b32 v179, v167
    s_nop 0
    v_max_f32 v176, v176, v166
    v_max_f32 v179, v179, v167
    v_xor_b32 v176, 0x80000000, v176
    v_xor_b32 v179, 0x80000000, v179
    v_and_b32 v177, 0xffff0000, v176
    v_and_b32 v180, 0xffff0000, v179
    v_sub_f32 v176, v176, v177
    v_sub_f32 v179, v179, v180
    v_and_b32 v178, 0xffff0000, v176
    v_and_b32 v181, 0xffff0000, v179
    v_sub_f32 v176, v176, v178
    v_sub_f32 v179, v179, v181
    v_lshrrev_b32 v177, 16, v177
    v_lshrrev_b32 v180, 16, v180
    v_or_b32 v177, v177, v178
    v_or_b32 v180, v180, v181
    v_lshrrev_b32 v176, 16, v176
    v_lshrrev_b32 v179, 16, v179
    v_cndmask_b32 v121, v176, v177, vcc
    v_cndmask_b32 v123, v179, v180, vcc
    s_nop 1
    v_mfma_f32_32x32x16_bf16 v[16:31], v[128:131], v[112:115], 0
    v_mfma_f32_32x32x8_bf16 v[16:31], v[134:135], v[120:121], v[16:31]
    v_mfma_f32_32x32x16_bf16 v[32:47], v[128:131], v[116:119], 0
    v_mfma_f32_32x32x8_bf16 v[32:47], v[134:135], v[122:123], v[32:47]
    v_mfma_f32_32x32x16_bf16 v[80:95], v[156:159], v[156:159], 0
    v_mfma_f32_32x32x16_bf16 v[96:111], v[156:159], v[156:159], 0
    s_waitcnt vmcnt(0) lgkmcnt(0)
    s_barrier
    ds_read_b128 v[124:127], v160 offset:1280
    ds_read_b32 v132, v161 offset:2304
    s_mov_b64 exec, s[4:5]
    ds_read_b128 v[136:139], v152 offset:0
    ds_read_b128 v[140:143], v152 offset:640
    s_mov_b64 exec, -1
    s_branch L_at_go
L_end1:
    s_endpgm
.section .rodata,"a"
.p2align 6
.amdhsa_kernel gated_mix__mha_block__linear_kernel_hedgehog__prompt_kernel
  .amdhsa_next_free_vgpr 256
  .amdhsa_next_free_sgpr 102
  .amdhsa_accum_offset 256
  .amdhsa_group_segment_fixed_size 0
  .amdhsa_kernarg_size 88
  .amdhsa_user_sgpr_count 2
  .amdhsa_user_sgpr_kernarg_segment_ptr 1
  .amdhsa_system_sgpr_workgroup_id_x 1
  .amdhsa_float_denorm_mode_32 3
  .amdhsa_float_denorm_mode_16_64 3
.end_amdhsa_kernel
```
